```python
import torch

def _softmax(x, axis=-1):
    return torch.softmax(x, dim=axis)
def _gelu(x):
    return torch.nn.functional.gelu(x, approximate="tanh")
def _silu(x):
    return torch.nn.functional.silu(x)
def _sigmoid(x):
    return torch.sigmoid(x)
def _layernorm(x, axis=-1, eps=1e-5):
    m = x.mean(dim=axis, keepdim=True)
    v = x.var(dim=axis, keepdim=True, unbiased=False)
    return (x - m) / torch.sqrt(v + eps)
def _scatter_add(tgt, idx, src, axis=0):
    return tgt.clone().index_add_(axis, idx, src)
def _segment_sum(src, seg, n):
    out = torch.zeros((n,) + src.shape[1:], dtype=src.dtype)
    return out.index_add_(0, seg, src)
def _pad(x, pw):
    flat = tuple(v for pair in reversed(pw) for v in pair)
    return torch.nn.functional.pad(x, flat)

kernel_name = 'concat_heads__gqa_block_cached__mha_block_cached__decode'

def setup_inputs():

    _w = (lambda a: (lambda t: t.to(torch.bfloat16) if t.is_floating_point() else t)(torch.as_tensor(a)))
    def _A_setup():
        B, Sq, D = 8, 1, 448
        Hq, Hkv, Sk, Dh = 16, 8, 4096, 256
        assert Hq % Hkv == 0, (Hq, Hkv)
        return {
            "x": _w((lambda *s: torch.randn(*s, dtype=torch.bfloat16) * 0.8)(B, Sq, D)),
            "k_cache": _w((lambda *s: torch.randn(*s, dtype=torch.bfloat16) * 0.8)(B, Hkv, Sk, Dh)),
            "v_cache": _w((lambda *s: torch.randn(*s, dtype=torch.bfloat16) * 0.05)(B, Hkv, Sk, Dh)),
            "wq": _w((lambda *s: torch.randn(*s, dtype=torch.bfloat16) * 0.8)(D, Hq * Dh) * (D ** -0.5)),
            "wo": _w((lambda *s: torch.randn(*s, dtype=torch.bfloat16) * 0.05)(Hq * Dh, D) * ((Hq * Dh) ** -0.5)),
        }
    _A_in = _A_setup()

    def _B_setup():
        B, Sq, D = 8, 1, 448
        H, Sk, Dh = 16, 4096, 256
        return {
            "x": _w((lambda *s: torch.randn(*s, dtype=torch.bfloat16) * 0.8)(B, Sq, D)),
            "k_cache": _w((lambda *s: torch.randn(*s, dtype=torch.bfloat16) * 0.8)(B, H, Sk, Dh)),
            "v_cache": _w((lambda *s: torch.randn(*s, dtype=torch.bfloat16) * 0.05)(B, H, Sk, Dh)),
            "wq": _w((lambda *s: torch.randn(*s, dtype=torch.bfloat16) * 0.8)(D, H * Dh) * (D ** -0.5)),
            "wo": _w((lambda *s: torch.randn(*s, dtype=torch.bfloat16) * 0.05)(H * Dh, D) * ((H * Dh) ** -0.5)),
        }
    _B_in = _B_setup()

    return {
        "A_x": _A_in["x"],
        "A_k_cache": _A_in["k_cache"],
        "A_v_cache": _A_in["v_cache"],
        "A_wq": _A_in["wq"],
        "A_wo": _A_in["wo"],
        "B_x": _B_in["x"],
        "B_k_cache": _B_in["k_cache"],
        "B_v_cache": _B_in["v_cache"],
        "B_wq": _B_in["wq"],
        "B_wo": _B_in["wo"],
    }

def reference(A_x, A_k_cache, A_v_cache, A_wq, A_wo, B_x, B_k_cache, B_v_cache, B_wq, B_wo):
    def _A_ref(x, k_cache, v_cache, wq, wo):
        B, Sq, D = x.shape
        Hq, Dh = 16, 256
        Hkv = k_cache.shape[1]
        rep = Hq // Hkv
        q = (lambda x, *d: x.permute(*d))((x @ wq).reshape(B, Sq, Hq, Dh), 0, 2, 1, 3)
        k = (lambda x, n, axis: torch.repeat_interleave(x, n, dim=axis))(k_cache, rep, axis=1)
        v = (lambda x, n, axis: torch.repeat_interleave(x, n, dim=axis))(v_cache, rep, axis=1)
        scores = torch.einsum("bhqd,bhkd->bhqk", q, k) * (Dh ** -0.5)
        p = _softmax(scores, axis=-1)
        o = torch.einsum("bhqk,bhkd->bhqd", p, v)
        return (lambda x, *d: x.permute(*d))(o, 0, 2, 1, 3).reshape(B, Sq, Hq * Dh) @ wo

    def _B_ref(x, k_cache, v_cache, wq, wo):
        B, Sq, D = x.shape
        H, Dh = 16, 256
        q = (lambda x, *d: x.permute(*d))((x @ wq).reshape(B, Sq, H, Dh), 0, 2, 1, 3)
        scores = torch.einsum("bhqd,bhkd->bhqk", q, k_cache) * (Dh ** -0.5)
        p = _softmax(scores, axis=-1)
        o = torch.einsum("bhqk,bhkd->bhqd", p, v_cache)
        return (lambda x, *d: x.permute(*d))(o, 0, 2, 1, 3).reshape(B, Sq, H * Dh) @ wo

    a = _A_ref(A_x, A_k_cache, A_v_cache, A_wq, A_wo)
    b = _B_ref(B_x, B_k_cache, B_v_cache, B_wq, B_wo)
    return torch.concatenate([a, b], axis=-1)
```

```asm
; @launch grid=(256,1,1) block=(256,1,1) lds=139264
.amdgcn_target "amdgcn-amd-amdhsa--gfx950"
.text
.globl concat_heads__gqa_block_cached__mha_block_cached__decode_kernel
.p2align 8
.type concat_heads__gqa_block_cached__mha_block_cached__decode_kernel,@function
concat_heads__gqa_block_cached__mha_block_cached__decode_kernel:
  s_cmp_ge_u32 s2, 256
  s_cbranch_scc1 L_end
  s_load_dwordx16 s[4:19], s[0:1], 0
  s_load_dwordx8 s[20:27], s[0:1], 64
  s_load_dwordx2 s[28:29], s[0:1], 96
  v_lshrrev_b32 v2, 6, v0
  v_and_b32 v1, 63, v0
  v_readfirstlane_b32 s3, v2
  s_waitcnt lgkmcnt(0)
  s_cmp_eq_u32 s3, 0
  s_cbranch_scc1 L_qslice
  s_cmp_lt_u32 s2, 64
  s_cbranch_scc1 L_h_join0
  s_branch L_unit_setup
L_qslice:
  s_setprio 3
  s_and_b32 s40, s2, 7
  s_lshl_b32 s40, s40, 5
  s_lshr_b32 s41, s2, 3
  s_add_u32 s40, s40, s41
  s_lshr_b32 s80, s40, 7
  s_and_b32 s81, s40, 127
  s_cmp_eq_u32 s80, 0
  s_cselect_b32 s72, s4, s14
  s_cselect_b32 s73, s5, s15
  s_cselect_b32 s76, s10, s20
  s_cselect_b32 s77, s11, s21
  s_and_b32 s73, s73, 0xffff
  s_and_b32 s77, s77, 0xffff
  s_mov_b32 s74, 7168
  s_mov_b32 s75, 0x20000
  s_mov_b32 s78, 3670016
  s_mov_b32 s79, 0x20000
  v_lshrrev_b32 v2, 2, v1
  v_lshlrev_b32 v2, 13, v2
  v_and_b32 v3, 3, v1
  v_lshl_add_u32 v2, v3, 4, v2
  s_lshl_b32 s41, s81, 6
  s_mov_b32 m0, 0
  s_mov_b32 s42, 28
L_qdma:
  buffer_load_dwordx4 v2, s[76:79], s41 offen nt lds
  s_add_u32 s41, s41, 131072
  s_add_u32 m0, m0, 1024
  s_sub_u32 s42, s42, 1
  s_cmp_lg_u32 s42, 0
  s_cbranch_scc1 L_qdma
  v_and_b32 v4, 7, v1
  v_mul_u32_u24 v4, 896, v4
  v_lshrrev_b32 v5, 4, v1
  v_lshl_add_u32 v4, v5, 4, v4
  buffer_load_dwordx4 v[48:51], v4, s[72:75], 0 offen offset:0
  buffer_load_dwordx4 v[52:55], v4, s[72:75], 0 offen offset:64
  buffer_load_dwordx4 v[56:59], v4, s[72:75], 0 offen offset:128
  buffer_load_dwordx4 v[60:63], v4, s[72:75], 0 offen offset:192
  buffer_load_dwordx4 v[64:67], v4, s[72:75], 0 offen offset:256
  buffer_load_dwordx4 v[68:71], v4, s[72:75], 0 offen offset:320
  buffer_load_dwordx4 v[72:75], v4, s[72:75], 0 offen offset:384
  buffer_load_dwordx4 v[76:79], v4, s[72:75], 0 offen offset:448
  buffer_load_dwordx4 v[80:83], v4, s[72:75], 0 offen offset:512
  buffer_load_dwordx4 v[84:87], v4, s[72:75], 0 offen offset:576
  buffer_load_dwordx4 v[88:91], v4, s[72:75], 0 offen offset:640
  buffer_load_dwordx4 v[92:95], v4, s[72:75], 0 offen offset:704
  buffer_load_dwordx4 v[96:99], v4, s[72:75], 0 offen offset:768
  buffer_load_dwordx4 v[100:103], v4, s[72:75], 0 offen offset:832
  v_mov_b32 v6, 0
  global_load_dwordx2 v[240:241], v6, s[28:29] offset:0 sc1
  s_barrier
  v_and_b32 v3, 15, v1
  v_lshrrev_b32 v6, 2, v3
  v_lshlrev_b32 v6, 6, v6
  v_and_b32 v7, 3, v3
  v_lshl_add_u32 v6, v7, 3, v6
  v_lshl_add_u32 v6, v5, 9, v6
  s_waitcnt vmcnt(0)
  v_readfirstlane_b32 s30, v240
  v_readfirstlane_b32 s31, v241
  ds_read_b64_tr_b16 v[112:113], v6 offset:0
  ds_read_b64_tr_b16 v[114:115], v6 offset:256
  ds_read_b64_tr_b16 v[116:117], v6 offset:32
  ds_read_b64_tr_b16 v[118:119], v6 offset:288
  ds_read_b64_tr_b16 v[120:121], v6 offset:2048
  ds_read_b64_tr_b16 v[122:123], v6 offset:2304
  ds_read_b64_tr_b16 v[124:125], v6 offset:2080
  ds_read_b64_tr_b16 v[126:127], v6 offset:2336
  ds_read_b64_tr_b16 v[128:129], v6 offset:4096
  ds_read_b64_tr_b16 v[130:131], v6 offset:4352
  ds_read_b64_tr_b16 v[132:133], v6 offset:4128
  ds_read_b64_tr_b16 v[134:135], v6 offset:4384
  s_add_u32 s30, s30, 1
  s_addc_u32 s31, s31, 0
  s_waitcnt lgkmcnt(8)
  v_mfma_f32_16x16x32_bf16 v[24:27], v[48:51], v[112:115], 0
  v_mfma_f32_16x16x32_bf16 v[28:31], v[48:51], v[116:119], 0
  ds_read_b64_tr_b16 v[136:137], v6 offset:6144
  ds_read_b64_tr_b16 v[138:139], v6 offset:6400
  ds_read_b64_tr_b16 v[140:141], v6 offset:6176
  ds_read_b64_tr_b16 v[142:143], v6 offset:6432
  s_waitcnt lgkmcnt(8)
  v_mfma_f32_16x16x32_bf16 v[24:27], v[52:55], v[120:123], v[24:27]
  v_mfma_f32_16x16x32_bf16 v[28:31], v[52:55], v[124:127], v[28:31]
  ds_read_b64_tr_b16 v[144:145], v6 offset:8192
  ds_read_b64_tr_b16 v[146:147], v6 offset:8448
  ds_read_b64_tr_b16 v[148:149], v6 offset:8224
  ds_read_b64_tr_b16 v[150:151], v6 offset:8480
  s_waitcnt lgkmcnt(8)
  v_mfma_f32_16x16x32_bf16 v[24:27], v[56:59], v[128:131], v[24:27]
  v_mfma_f32_16x16x32_bf16 v[28:31], v[56:59], v[132:135], v[28:31]
  ds_read_b64_tr_b16 v[152:153], v6 offset:10240
  ds_read_b64_tr_b16 v[154:155], v6 offset:10496
  ds_read_b64_tr_b16 v[156:157], v6 offset:10272
  ds_read_b64_tr_b16 v[158:159], v6 offset:10528
  s_waitcnt lgkmcnt(8)
  v_mfma_f32_16x16x32_bf16 v[24:27], v[60:63], v[136:139], v[24:27]
  v_mfma_f32_16x16x32_bf16 v[28:31], v[60:63], v[140:143], v[28:31]
  ds_read_b64_tr_b16 v[160:161], v6 offset:12288
  ds_read_b64_tr_b16 v[162:163], v6 offset:12544
  ds_read_b64_tr_b16 v[164:165], v6 offset:12320
  ds_read_b64_tr_b16 v[166:167], v6 offset:12576
  s_waitcnt lgkmcnt(8)
  v_mfma_f32_16x16x32_bf16 v[24:27], v[64:67], v[144:147], v[24:27]
  v_mfma_f32_16x16x32_bf16 v[28:31], v[64:67], v[148:151], v[28:31]
  ds_read_b64_tr_b16 v[168:169], v6 offset:14336
  ds_read_b64_tr_b16 v[170:171], v6 offset:14592
  ds_read_b64_tr_b16 v[172:173], v6 offset:14368
  ds_read_b64_tr_b16 v[174:175], v6 offset:14624
  s_waitcnt lgkmcnt(8)
  v_mfma_f32_16x16x32_bf16 v[24:27], v[68:71], v[152:155], v[24:27]
  v_mfma_f32_16x16x32_bf16 v[28:31], v[68:71], v[156:159], v[28:31]
  ds_read_b64_tr_b16 v[176:177], v6 offset:16384
  ds_read_b64_tr_b16 v[178:179], v6 offset:16640
  ds_read_b64_tr_b16 v[180:181], v6 offset:16416
  ds_read_b64_tr_b16 v[182:183], v6 offset:16672
  s_waitcnt lgkmcnt(8)
  v_mfma_f32_16x16x32_bf16 v[24:27], v[72:75], v[160:163], v[24:27]
  v_mfma_f32_16x16x32_bf16 v[28:31], v[72:75], v[164:167], v[28:31]
  ds_read_b64_tr_b16 v[184:185], v6 offset:18432
  ds_read_b64_tr_b16 v[186:187], v6 offset:18688
  ds_read_b64_tr_b16 v[188:189], v6 offset:18464
  ds_read_b64_tr_b16 v[190:191], v6 offset:18720
  s_waitcnt lgkmcnt(8)
  v_mfma_f32_16x16x32_bf16 v[24:27], v[76:79], v[168:171], v[24:27]
  v_mfma_f32_16x16x32_bf16 v[28:31], v[76:79], v[172:175], v[28:31]
  ds_read_b64_tr_b16 v[192:193], v6 offset:20480
  ds_read_b64_tr_b16 v[194:195], v6 offset:20736
  ds_read_b64_tr_b16 v[196:197], v6 offset:20512
  ds_read_b64_tr_b16 v[198:199], v6 offset:20768
  s_waitcnt lgkmcnt(8)
  v_mfma_f32_16x16x32_bf16 v[24:27], v[80:83], v[176:179], v[24:27]
  v_mfma_f32_16x16x32_bf16 v[28:31], v[80:83], v[180:183], v[28:31]
  ds_read_b64_tr_b16 v[200:201], v6 offset:22528
  ds_read_b64_tr_b16 v[202:203], v6 offset:22784
  ds_read_b64_tr_b16 v[204:205], v6 offset:22560
  ds_read_b64_tr_b16 v[206:207], v6 offset:22816
  s_waitcnt lgkmcnt(8)
  v_mfma_f32_16x16x32_bf16 v[24:27], v[84:87], v[184:187], v[24:27]
  v_mfma_f32_16x16x32_bf16 v[28:31], v[84:87], v[188:191], v[28:31]
  ds_read_b64_tr_b16 v[208:209], v6 offset:24576
  ds_read_b64_tr_b16 v[210:211], v6 offset:24832
  ds_read_b64_tr_b16 v[212:213], v6 offset:24608
  ds_read_b64_tr_b16 v[214:215], v6 offset:24864
  s_waitcnt lgkmcnt(8)
  v_mfma_f32_16x16x32_bf16 v[24:27], v[88:91], v[192:195], v[24:27]
  v_mfma_f32_16x16x32_bf16 v[28:31], v[88:91], v[196:199], v[28:31]
  ds_read_b64_tr_b16 v[216:217], v6 offset:26624
  ds_read_b64_tr_b16 v[218:219], v6 offset:26880
  ds_read_b64_tr_b16 v[220:221], v6 offset:26656
  ds_read_b64_tr_b16 v[222:223], v6 offset:26912
  s_waitcnt lgkmcnt(8)
  v_mfma_f32_16x16x32_bf16 v[24:27], v[92:95], v[200:203], v[24:27]
  v_mfma_f32_16x16x32_bf16 v[28:31], v[92:95], v[204:207], v[28:31]
  s_waitcnt lgkmcnt(4)
  v_mfma_f32_16x16x32_bf16 v[24:27], v[96:99], v[208:211], v[24:27]
  v_mfma_f32_16x16x32_bf16 v[28:31], v[96:99], v[212:215], v[28:31]
  s_waitcnt lgkmcnt(0)
  v_mfma_f32_16x16x32_bf16 v[24:27], v[100:103], v[216:219], v[24:27]
  v_mfma_f32_16x16x32_bf16 v[28:31], v[100:103], v[220:223], v[28:31]
  v_lshlrev_b32 v6, 9, v5
  v_lshl_add_u32 v6, v3, 2, v6
  v_add_u32 v6, 133120, v6
  s_nop 7
  s_mov_b32 exec_hi, 0
  ds_write_b32 v6, v24 offset:0
  ds_write_b32 v6, v25 offset:128
  ds_write_b32 v6, v26 offset:256
  ds_write_b32 v6, v27 offset:384
  ds_write_b32 v6, v28 offset:64
  ds_write_b32 v6, v29 offset:192
  ds_write_b32 v6, v30 offset:320
  ds_write_b32 v6, v31 offset:448
  s_mov_b64 exec, -1
  v_lshlrev_b32 v6, 4, v1
  v_add_u32 v6, 133120, v6
  s_waitcnt lgkmcnt(0)
  ds_read_b128 v[32:35], v6
  v_lshrrev_b32 v6, 3, v1
  v_lshlrev_b32 v6, 14, v6
  v_and_b32 v7, 7, v1
  v_lshl_add_u32 v6, v7, 4, v6
  s_lshl_b32 s41, s80, 17
  s_lshl_b32 s42, s81, 7
  s_add_u32 s41, s41, s42
  s_add_u32 s41, s41, 65536
  s_add_u32 s82, s28, s41
  s_addc_u32 s83, s29, 0
  v_mov_b32 v38, s30
  v_mov_b32 v39, s31
  s_waitcnt lgkmcnt(0)
  v_cvt_pk_bf16_f32 v36, v32, v33
  v_cvt_pk_bf16_f32 v37, v34, v35
  global_store_dwordx4 v6, v[36:39], s[82:83] sc1
  s_cmp_lt_u32 s2, 64
  s_cbranch_scc1 L_helper0
L_unit_setup:
  s_sub_u32 s40, s2, 64
  s_cmp_lt_u32 s40, 64
  s_cselect_b32 s52, 1, 0
  s_cselect_b32 s32, s6, s16
  s_cselect_b32 s33, s7, s17
  s_cselect_b32 s36, s8, s18
  s_cselect_b32 s37, s9, s19
  s_cselect_b32 s41, 0, 64
  s_sub_u32 s40, s40, s41
  s_lshl_b32 s41, s40, 21
  s_add_u32 s32, s32, s41
  s_addc_u32 s33, s33, 0
  s_add_u32 s36, s36, s41
  s_addc_u32 s37, s37, 0
  s_and_b32 s33, s33, 0xffff
  s_and_b32 s37, s37, 0xffff
  s_mov_b32 s34, 0x200000
  s_mov_b32 s35, 0x20000
  s_mov_b32 s38, 0x200000
  s_mov_b32 s39, 0x20000
  s_lshl_b32 s43, s3, 15
  v_lshrrev_b32 v2, 5, v1
  v_and_b32 v3, 31, v1
  v_lshlrev_b32 v23, 2, v2
  v_xor_b32 v3, v3, v23
  v_lshlrev_b32 v3, 4, v3
  v_lshl_add_u32 v3, v2, 9, v3
  v_xor_b32 v4, 0, v3
  v_xor_b32 v5, 128, v3
  v_xor_b32 v6, 16, v3
  v_xor_b32 v7, 144, v3
  v_xor_b32 v8, 32, v3
  v_xor_b32 v9, 160, v3
  v_xor_b32 v10, 48, v3
  v_xor_b32 v11, 176, v3
  v_lshrrev_b32 v2, 4, v1
  v_and_b32 v3, 15, v1
  v_lshlrev_b32 v23, 4, v3
  v_lshl_add_u32 v12, v2, 9, v23
  s_cmp_eq_u32 s3, 0
  s_cbranch_scc1 L_u_rest
  s_barrier
  s_lshl_b32 s40, s3, 14
  s_add_u32 s47, s40, 0x10000
  s_add_u32 s42, s40, 0
  s_add_u32 m0, s43, 0
  s_nop 0
  buffer_load_dwordx4 v4, s[32:35], s42 offen offset:0 nt lds
  buffer_load_dwordx4 v5, s[32:35], s42 offen offset:1024 nt lds
  buffer_load_dwordx4 v6, s[32:35], s42 offen offset:2048 nt lds
  buffer_load_dwordx4 v7, s[32:35], s42 offen offset:3072 nt lds
  s_add_u32 s42, s40, 4096
  s_add_u32 m0, s43, 4096
  s_nop 0
  buffer_load_dwordx4 v8, s[32:35], s42 offen offset:0 nt lds
  buffer_load_dwordx4 v9, s[32:35], s42 offen offset:1024 nt lds
  buffer_load_dwordx4 v10, s[32:35], s42 offen offset:2048 nt lds
  buffer_load_dwordx4 v11, s[32:35], s42 offen offset:3072 nt lds
  s_add_u32 s42, s40, 8192
  s_add_u32 m0, s43, 8192
  s_nop 0
  buffer_load_dwordx4 v4, s[32:35], s42 offen offset:0 nt lds
  buffer_load_dwordx4 v5, s[32:35], s42 offen offset:1024 nt lds
  buffer_load_dwordx4 v6, s[32:35], s42 offen offset:2048 nt lds
  buffer_load_dwordx4 v7, s[32:35], s42 offen offset:3072 nt lds
  s_add_u32 s42, s40, 12288
  s_add_u32 m0, s43, 12288
  s_nop 0
  buffer_load_dwordx4 v8, s[32:35], s42 offen offset:0 nt lds
  buffer_load_dwordx4 v9, s[32:35], s42 offen offset:1024 nt lds
  buffer_load_dwordx4 v10, s[32:35], s42 offen offset:2048 nt lds
  buffer_load_dwordx4 v11, s[32:35], s42 offen offset:3072 nt lds
  s_add_u32 s42, s40, 0
  buffer_load_dwordx4 v[112:115], v12, s[36:39], s42 offen offset:0 nt
  buffer_load_dwordx4 v[116:119], v12, s[36:39], s42 offen offset:256 nt
  buffer_load_dwordx4 v[120:123], v12, s[36:39], s42 offen offset:2048 nt
  buffer_load_dwordx4 v[124:127], v12, s[36:39], s42 offen offset:2304 nt
  s_add_u32 s42, s40, 4096
  buffer_load_dwordx4 v[128:131], v12, s[36:39], s42 offen offset:0 nt
  buffer_load_dwordx4 v[132:135], v12, s[36:39], s42 offen offset:256 nt
  buffer_load_dwordx4 v[136:139], v12, s[36:39], s42 offen offset:2048 nt
  buffer_load_dwordx4 v[140:143], v12, s[36:39], s42 offen offset:2304 nt
  s_add_u32 s42, s40, 8192
  buffer_load_dwordx4 v[144:147], v12, s[36:39], s42 offen offset:0 nt
  buffer_load_dwordx4 v[148:151], v12, s[36:39], s42 offen offset:256 nt
  buffer_load_dwordx4 v[152:155], v12, s[36:39], s42 offen offset:2048 nt
  buffer_load_dwordx4 v[156:159], v12, s[36:39], s42 offen offset:2304 nt
  s_add_u32 s42, s40, 12288
  buffer_load_dwordx4 v[160:163], v12, s[36:39], s42 offen offset:0 nt
  buffer_load_dwordx4 v[164:167], v12, s[36:39], s42 offen offset:256 nt
  buffer_load_dwordx4 v[168:171], v12, s[36:39], s42 offen offset:2048 nt
  buffer_load_dwordx4 v[172:175], v12, s[36:39], s42 offen offset:2304 nt
  s_add_u32 s42, s47, 0
  s_add_u32 m0, s43, 16384
  s_nop 0
  buffer_load_dwordx4 v4, s[32:35], s42 offen offset:0 nt lds
  buffer_load_dwordx4 v5, s[32:35], s42 offen offset:1024 nt lds
  buffer_load_dwordx4 v6, s[32:35], s42 offen offset:2048 nt lds
  buffer_load_dwordx4 v7, s[32:35], s42 offen offset:3072 nt lds
  s_add_u32 s42, s47, 4096
  s_add_u32 m0, s43, 20480
  s_nop 0
  buffer_load_dwordx4 v8, s[32:35], s42 offen offset:0 nt lds
  buffer_load_dwordx4 v9, s[32:35], s42 offen offset:1024 nt lds
  buffer_load_dwordx4 v10, s[32:35], s42 offen offset:2048 nt lds
  buffer_load_dwordx4 v11, s[32:35], s42 offen offset:3072 nt lds
  s_add_u32 s42, s47, 8192
  s_add_u32 m0, s43, 24576
  s_nop 0
  buffer_load_dwordx4 v4, s[32:35], s42 offen offset:0 nt lds
  buffer_load_dwordx4 v5, s[32:35], s42 offen offset:1024 nt lds
  buffer_load_dwordx4 v6, s[32:35], s42 offen offset:2048 nt lds
  buffer_load_dwordx4 v7, s[32:35], s42 offen offset:3072 nt lds
  s_add_u32 s42, s47, 12288
  s_add_u32 m0, s43, 28672
  s_nop 0
  buffer_load_dwordx4 v8, s[32:35], s42 offen offset:0 nt lds
  buffer_load_dwordx4 v9, s[32:35], s42 offen offset:1024 nt lds
  buffer_load_dwordx4 v10, s[32:35], s42 offen offset:2048 nt lds
  buffer_load_dwordx4 v11, s[32:35], s42 offen offset:3072 nt lds
  s_add_u32 s42, s47, 0
  buffer_load_dwordx4 v[176:179], v12, s[36:39], s42 offen offset:0 nt
  buffer_load_dwordx4 v[180:183], v12, s[36:39], s42 offen offset:256 nt
  buffer_load_dwordx4 v[184:187], v12, s[36:39], s42 offen offset:2048 nt
  buffer_load_dwordx4 v[188:191], v12, s[36:39], s42 offen offset:2304 nt
  s_add_u32 s42, s47, 4096
  buffer_load_dwordx4 v[192:195], v12, s[36:39], s42 offen offset:0 nt
  buffer_load_dwordx4 v[196:199], v12, s[36:39], s42 offen offset:256 nt
  buffer_load_dwordx4 v[200:203], v12, s[36:39], s42 offen offset:2048 nt
  buffer_load_dwordx4 v[204:207], v12, s[36:39], s42 offen offset:2304 nt
  s_add_u32 s42, s47, 8192
  buffer_load_dwordx4 v[208:211], v12, s[36:39], s42 offen offset:0 nt
  buffer_load_dwordx4 v[212:215], v12, s[36:39], s42 offen offset:256 nt
  buffer_load_dwordx4 v[216:219], v12, s[36:39], s42 offen offset:2048 nt
  buffer_load_dwordx4 v[220:223], v12, s[36:39], s42 offen offset:2304 nt
  s_add_u32 s42, s47, 12288
  buffer_load_dwordx4 v[224:227], v12, s[36:39], s42 offen offset:0 nt
  buffer_load_dwordx4 v[228:231], v12, s[36:39], s42 offen offset:256 nt
  buffer_load_dwordx4 v[232:235], v12, s[36:39], s42 offen offset:2048 nt
  buffer_load_dwordx4 v[236:239], v12, s[36:39], s42 offen offset:2304 nt
L_u_rest:
  s_sub_u32 s40, s2, 64
  s_cmp_lg_u32 s52, 0
  s_cselect_b32 s41, 0, 64
  s_sub_u32 s40, s40, s41
  s_cmp_lg_u32 s52, 0
  s_cselect_b32 s41, 3, 4
  s_cselect_b32 s47, 7, 15
  s_cselect_b32 s54, 11, 10
  s_cselect_b32 s55, 0, 0x20000
  s_cselect_b32 s68, 10, 9
  s_cselect_b32 s69, 0, 0x10000
  s_lshr_b32 s42, s40, s41
  s_and_b32 s53, s40, s47
  s_lshl_b32 s41, s53, s54
  s_lshl_b32 s47, s42, 14
  s_add_u32 s41, s41, s47
  s_add_u32 s41, s41, s55
  s_add_u32 s41, s41, 65536
  s_add_u32 s48, s28, s41
  s_addc_u32 s49, s29, 0
  s_lshl_b32 s41, s53, s68
  s_lshl_b32 s47, s42, 13
  s_add_u32 s41, s41, s47
  s_add_u32 s41, s41, s69
  s_add_u32 s41, s41, 393216
  s_add_u32 s50, s28, s41
  s_addc_u32 s51, s29, 0
  s_mov_b32 s44, 1035512379
  s_mov_b32 s45, 0x05040100
  s_mov_b32 s46, 0x07060302
  v_and_b32 v23, 3, v3
  v_lshlrev_b32 v23, 2, v23
  v_lshrrev_b32 v242, 2, v3
  v_add_u32 v23, v23, v242
  v_lshlrev_b32 v23, 9, v23
  v_add_u32 v23, s43, v23
  v_add_u32 v242, 0, v2
  v_xor_b32 v242, v242, v3
  v_lshl_add_u32 v13, v242, 4, v23
  v_add_u32 v242, 4, v2
  v_xor_b32 v242, v242, v3
  v_lshl_add_u32 v14, v242, 4, v23
  v_add_u32 v242, 8, v2
  v_xor_b32 v242, v242, v3
  v_lshl_add_u32 v15, v242, 4, v23
  v_add_u32 v242, 12, v2
  v_xor_b32 v242, v242, v3
  v_lshl_add_u32 v16, v242, 4, v23
  v_mov_b32 v21, 132096
  v_mov_b32 v22, 1
  v_cmp_eq_u32 vcc, 0, v1
  v_mov_b32 v18, 0xff800000
  v_mov_b32 v19, 0
  v_cndmask_b32 v17, 0, 1, vcc
  v_mov_b32 v20, 0
  v_mov_b32 v48, 0
  v_mov_b32 v49, 0
  v_mov_b32 v50, 0
  v_mov_b32 v51, 0
  v_mov_b32 v52, 0
  v_mov_b32 v53, 0
  v_mov_b32 v54, 0
  v_mov_b32 v55, 0
  v_mov_b32 v56, 0
  v_mov_b32 v57, 0
  v_mov_b32 v58, 0
  v_mov_b32 v59, 0
  v_mov_b32 v60, 0
  v_mov_b32 v61, 0
  v_mov_b32 v62, 0
  v_mov_b32 v63, 0
  v_mov_b32 v64, 0
  v_mov_b32 v65, 0
  v_mov_b32 v66, 0
  v_mov_b32 v67, 0
  v_mov_b32 v68, 0
  v_mov_b32 v69, 0
  v_mov_b32 v70, 0
  v_mov_b32 v71, 0
  v_mov_b32 v72, 0
  v_mov_b32 v73, 0
  v_mov_b32 v74, 0
  v_mov_b32 v75, 0
  v_mov_b32 v76, 0
  v_mov_b32 v77, 0
  v_mov_b32 v78, 0
  v_mov_b32 v79, 0
  v_mov_b32 v80, 0
  v_mov_b32 v81, 0
  v_mov_b32 v82, 0
  v_mov_b32 v83, 0
  v_mov_b32 v84, 0
  v_mov_b32 v85, 0
  v_mov_b32 v86, 0
  v_mov_b32 v87, 0
  v_mov_b32 v88, 0
  v_mov_b32 v89, 0
  v_mov_b32 v90, 0
  v_mov_b32 v91, 0
  v_mov_b32 v92, 0
  v_mov_b32 v93, 0
  v_mov_b32 v94, 0
  v_mov_b32 v95, 0
  v_mov_b32 v96, 0
  v_mov_b32 v97, 0
  v_mov_b32 v98, 0
  v_mov_b32 v99, 0
  v_mov_b32 v100, 0
  v_mov_b32 v101, 0
  v_mov_b32 v102, 0
  v_mov_b32 v103, 0
  v_mov_b32 v104, 0
  v_mov_b32 v105, 0
  v_mov_b32 v106, 0
  v_mov_b32 v107, 0
  v_mov_b32 v108, 0
  v_mov_b32 v109, 0
  v_mov_b32 v110, 0
  v_mov_b32 v111, 0
  s_cmp_lg_u32 s3, 0
  s_cbranch_scc1 L_u_bar
  v_lshlrev_b32 v2, 4, v1
  s_cmp_lg_u32 s52, 0
  s_cselect_b32 s41, 1024, 0
  v_add_u32 v3, s41, v2
  s_mov_b32 s56, 262144
L_u_poll:
  global_load_dwordx4 v[24:27], v2, s[48:49] sc1
  global_load_dwordx4 v[28:31], v3, s[48:49] sc1
  s_waitcnt vmcnt(0)
  v_cmp_eq_u32 vcc, s30, v26
  v_cmp_eq_u32 s[54:55], s31, v27
  v_cmp_eq_u32 s[68:69], s30, v30
  v_cmp_eq_u32 s[70:71], s31, v31
  s_nop 1
  s_and_b64 s[54:55], s[54:55], vcc
  s_and_b64 s[68:69], s[68:69], s[70:71]
  s_and_b64 s[54:55], s[54:55], s[68:69]
  s_cmp_eq_u64 s[54:55], -1
  s_cbranch_scc1 L_u_qready
  s_sleep 1
  s_sub_u32 s56, s56, 1
  s_cmp_lg_u32 s56, 0
  s_cbranch_scc1 L_u_poll
L_u_qready:
  v_lshlrev_b32 v2, 3, v1
  v_add_u32 v2, 131072, v2
  ds_write_b64 v2, v[24:25]
  ds_write_b64 v2, v[28:29] offset:512
  v_mov_b32 v2, 8
  v_mov_b32 v3, s30
  ds_write_b64 v21, v[2:3]
  s_setprio 0
  s_waitcnt lgkmcnt(0)
  s_barrier
  s_lshl_b32 s40, s3, 14
  s_add_u32 s47, s40, 0x10000
  s_add_u32 s42, s40, 0
  s_add_u32 m0, s43, 0
  s_nop 0
  buffer_load_dwordx4 v4, s[32:35], s42 offen offset:0 nt lds
  buffer_load_dwordx4 v5, s[32:35], s42 offen offset:1024 nt lds
  buffer_load_dwordx4 v6, s[32:35], s42 offen offset:2048 nt lds
  buffer_load_dwordx4 v7, s[32:35], s42 offen offset:3072 nt lds
  s_add_u32 s42, s40, 4096
  s_add_u32 m0, s43, 4096
  s_nop 0
  buffer_load_dwordx4 v8, s[32:35], s42 offen offset:0 nt lds
  buffer_load_dwordx4 v9, s[32:35], s42 offen offset:1024 nt lds
  buffer_load_dwordx4 v10, s[32:35], s42 offen offset:2048 nt lds
  buffer_load_dwordx4 v11, s[32:35], s42 offen offset:3072 nt lds
  s_add_u32 s42, s40, 8192
  s_add_u32 m0, s43, 8192
  s_nop 0
  buffer_load_dwordx4 v4, s[32:35], s42 offen offset:0 nt lds
  buffer_load_dwordx4 v5, s[32:35], s42 offen offset:1024 nt lds
  buffer_load_dwordx4 v6, s[32:35], s42 offen offset:2048 nt lds
  buffer_load_dwordx4 v7, s[32:35], s42 offen offset:3072 nt lds
  s_add_u32 s42, s40, 12288
  s_add_u32 m0, s43, 12288
  s_nop 0
  buffer_load_dwordx4 v8, s[32:35], s42 offen offset:0 nt lds
  buffer_load_dwordx4 v9, s[32:35], s42 offen offset:1024 nt lds
  buffer_load_dwordx4 v10, s[32:35], s42 offen offset:2048 nt lds
  buffer_load_dwordx4 v11, s[32:35], s42 offen offset:3072 nt lds
  s_add_u32 s42, s40, 0
  buffer_load_dwordx4 v[112:115], v12, s[36:39], s42 offen offset:0 nt
  buffer_load_dwordx4 v[116:119], v12, s[36:39], s42 offen offset:256 nt
  buffer_load_dwordx4 v[120:123], v12, s[36:39], s42 offen offset:2048 nt
  buffer_load_dwordx4 v[124:127], v12, s[36:39], s42 offen offset:2304 nt
  s_add_u32 s42, s40, 4096
  buffer_load_dwordx4 v[128:131], v12, s[36:39], s42 offen offset:0 nt
  buffer_load_dwordx4 v[132:135], v12, s[36:39], s42 offen offset:256 nt
  buffer_load_dwordx4 v[136:139], v12, s[36:39], s42 offen offset:2048 nt
  buffer_load_dwordx4 v[140:143], v12, s[36:39], s42 offen offset:2304 nt
  s_add_u32 s42, s40, 8192
  buffer_load_dwordx4 v[144:147], v12, s[36:39], s42 offen offset:0 nt
  buffer_load_dwordx4 v[148:151], v12, s[36:39], s42 offen offset:256 nt
  buffer_load_dwordx4 v[152:155], v12, s[36:39], s42 offen offset:2048 nt
  buffer_load_dwordx4 v[156:159], v12, s[36:39], s42 offen offset:2304 nt
  s_add_u32 s42, s40, 12288
  buffer_load_dwordx4 v[160:163], v12, s[36:39], s42 offen offset:0 nt
  buffer_load_dwordx4 v[164:167], v12, s[36:39], s42 offen offset:256 nt
  buffer_load_dwordx4 v[168:171], v12, s[36:39], s42 offen offset:2048 nt
  buffer_load_dwordx4 v[172:175], v12, s[36:39], s42 offen offset:2304 nt
  s_add_u32 s42, s47, 0
  s_add_u32 m0, s43, 16384
  s_nop 0
  buffer_load_dwordx4 v4, s[32:35], s42 offen offset:0 nt lds
  buffer_load_dwordx4 v5, s[32:35], s42 offen offset:1024 nt lds
  buffer_load_dwordx4 v6, s[32:35], s42 offen offset:2048 nt lds
  buffer_load_dwordx4 v7, s[32:35], s42 offen offset:3072 nt lds
  s_add_u32 s42, s47, 4096
  s_add_u32 m0, s43, 20480
  s_nop 0
  buffer_load_dwordx4 v8, s[32:35], s42 offen offset:0 nt lds
  buffer_load_dwordx4 v9, s[32:35], s42 offen offset:1024 nt lds
  buffer_load_dwordx4 v10, s[32:35], s42 offen offset:2048 nt lds
  buffer_load_dwordx4 v11, s[32:35], s42 offen offset:3072 nt lds
  s_add_u32 s42, s47, 8192
  s_add_u32 m0, s43, 24576
  s_nop 0
  buffer_load_dwordx4 v4, s[32:35], s42 offen offset:0 nt lds
  buffer_load_dwordx4 v5, s[32:35], s42 offen offset:1024 nt lds
  buffer_load_dwordx4 v6, s[32:35], s42 offen offset:2048 nt lds
  buffer_load_dwordx4 v7, s[32:35], s42 offen offset:3072 nt lds
  s_add_u32 s42, s47, 12288
  s_add_u32 m0, s43, 28672
  s_nop 0
  buffer_load_dwordx4 v8, s[32:35], s42 offen offset:0 nt lds
  buffer_load_dwordx4 v9, s[32:35], s42 offen offset:1024 nt lds
  buffer_load_dwordx4 v10, s[32:35], s42 offen offset:2048 nt lds
  buffer_load_dwordx4 v11, s[32:35], s42 offen offset:3072 nt lds
  s_add_u32 s42, s47, 0
  buffer_load_dwordx4 v[176:179], v12, s[36:39], s42 offen offset:0 nt
  buffer_load_dwordx4 v[180:183], v12, s[36:39], s42 offen offset:256 nt
  buffer_load_dwordx4 v[184:187], v12, s[36:39], s42 offen offset:2048 nt
  buffer_load_dwordx4 v[188:191], v12, s[36:39], s42 offen offset:2304 nt
  s_add_u32 s42, s47, 4096
  buffer_load_dwordx4 v[192:195], v12, s[36:39], s42 offen offset:0 nt
  buffer_load_dwordx4 v[196:199], v12, s[36:39], s42 offen offset:256 nt
  buffer_load_dwordx4 v[200:203], v12, s[36:39], s42 offen offset:2048 nt
  buffer_load_dwordx4 v[204:207], v12, s[36:39], s42 offen offset:2304 nt
  s_add_u32 s42, s47, 8192
  buffer_load_dwordx4 v[208:211], v12, s[36:39], s42 offen offset:0 nt
  buffer_load_dwordx4 v[212:215], v12, s[36:39], s42 offen offset:256 nt
  buffer_load_dwordx4 v[216:219], v12, s[36:39], s42 offen offset:2048 nt
  buffer_load_dwordx4 v[220:223], v12, s[36:39], s42 offen offset:2304 nt
  s_add_u32 s42, s47, 12288
  buffer_load_dwordx4 v[224:227], v12, s[36:39], s42 offen offset:0 nt
  buffer_load_dwordx4 v[228:231], v12, s[36:39], s42 offen offset:256 nt
  buffer_load_dwordx4 v[232:235], v12, s[36:39], s42 offen offset:2048 nt
  buffer_load_dwordx4 v[236:239], v12, s[36:39], s42 offen offset:2304 nt
  s_branch L_u_go
L_u_bar:
  s_barrier
L_u_go:
  v_and_b32 v2, 1, v1
  v_lshlrev_b32 v2, 9, v2
  v_lshrrev_b32 v3, 4, v1
  v_lshl_add_u32 v2, v3, 4, v2
  v_add_u32 v2, 131072, v2
  ds_read_b128 a[64:67], v2 offset:0
  ds_read_b128 a[68:71], v2 offset:64
  ds_read_b128 a[72:75], v2 offset:128
  ds_read_b128 a[76:79], v2 offset:192
  ds_read_b128 a[80:83], v2 offset:256
  ds_read_b128 a[84:87], v2 offset:320
  ds_read_b128 a[88:91], v2 offset:384
  ds_read_b128 a[92:95], v2 offset:448
  s_mov_b32 s71, 0
  s_waitcnt lgkmcnt(0)
  s_waitcnt vmcnt(48)
  ds_read_b128 a[0:3], v13 offset:0
  ds_read_b128 a[4:7], v13 offset:8192
  ds_read_b128 a[8:11], v14 offset:0
  ds_read_b128 a[12:15], v14 offset:8192
  ds_read_b128 a[16:19], v15 offset:0
  ds_read_b128 a[20:23], v15 offset:8192
  ds_read_b128 a[24:27], v16 offset:0
  ds_read_b128 a[28:31], v16 offset:8192
  ds_read_b128 a[32:35], v13 offset:256
  ds_read_b128 a[36:39], v13 offset:8448
  ds_read_b128 a[40:43], v14 offset:256
  ds_read_b128 a[44:47], v14 offset:8448
  s_waitcnt lgkmcnt(8)
  v_mfma_f32_16x16x32_bf16 v[24:27], a[0:3], a[64:67], 0
  v_mfma_f32_16x16x32_bf16 v[28:31], a[4:7], a[64:67], 0
  v_mfma_f32_16x16x32_bf16 v[24:27], a[8:11], a[68:71], v[24:27]
  v_mfma_f32_16x16x32_bf16 v[28:31], a[12:15], a[68:71], v[28:31]
  ds_read_b128 a[48:51], v15 offset:256
  ds_read_b128 a[52:55], v15 offset:8448
  ds_read_b128 a[56:59], v16 offset:256
  ds_read_b128 a[60:63], v16 offset:8448
  s_waitcnt lgkmcnt(8)
  v_mfma_f32_16x16x32_bf16 v[24:27], a[16:19], a[72:75], v[24:27]
  v_mfma_f32_16x16x32_bf16 v[28:31], a[20:23], a[72:75], v[28:31]
  v_mfma_f32_16x16x32_bf16 v[24:27], a[24:27], a[76:79], v[24:27]
  v_mfma_f32_16x16x32_bf16 v[28:31], a[28:31], a[76:79], v[28:31]
  s_waitcnt lgkmcnt(4)
  v_mfma_f32_16x16x32_bf16 v[24:27], a[32:35], a[80:83], v[24:27]
  v_mfma_f32_16x16x32_bf16 v[28:31], a[36:39], a[80:83], v[28:31]
  v_mfma_f32_16x16x32_bf16 v[24:27], a[40:43], a[84:87], v[24:27]
  v_mfma_f32_16x16x32_bf16 v[28:31], a[44:47], a[84:87], v[28:31]
  s_waitcnt lgkmcnt(0)
  v_mfma_f32_16x16x32_bf16 v[24:27], a[48:51], a[88:91], v[24:27]
  v_mfma_f32_16x16x32_bf16 v[28:31], a[52:55], a[88:91], v[28:31]
  v_mfma_f32_16x16x32_bf16 v[24:27], a[56:59], a[92:95], v[24:27]
  v_mfma_f32_16x16x32_bf16 v[28:31], a[60:63], a[92:95], v[28:31]
  s_nop 7
  v_cvt_pk_bf16_f32 v32, v24, v25
  v_cvt_pk_bf16_f32 v33, v26, v27
  v_cvt_pk_bf16_f32 v34, v28, v29
  v_cvt_pk_bf16_f32 v35, v30, v31
  v_lshlrev_b32 v24, 16, v32
  v_and_b32 v25, 0xffff0000, v32
  v_lshlrev_b32 v26, 16, v33
  v_and_b32 v27, 0xffff0000, v33
  v_lshlrev_b32 v28, 16, v34
  v_and_b32 v29, 0xffff0000, v34
  v_lshlrev_b32 v30, 16, v35
  v_and_b32 v31, 0xffff0000, v35
  v_max3_f32 v240, v24, v25, v26
  v_max3_f32 v241, v27, v28, v29
  v_max3_f32 v240, v30, v31, v240
  v_max_f32 v240, v240, v241
  v_mov_b32 v241, v240
  s_nop 1
  v_permlane16_swap_b32 v241, v240
  v_max_f32 v240, v240, v241
  v_mov_b32 v241, v240
  s_nop 1
  v_permlane32_swap_b32 v241, v240
  v_max3_f32 v240, v240, v241, v18
  v_cmp_gt_f32 vcc, v240, v18
  s_cbranch_vccz L_norescale_1
  v_sub_f32 v241, v18, v240
  v_mul_f32 v241, s44, v241
  v_exp_f32 v241, v241
  v_mov_b32 v18, v240
  v_mul_f32 v20, s44, v240
  v_mul_f32 v19, v19, v241
  v_sub_f32 v20, 0, v20
  v_mul_f32 v48, v48, v241
  v_mul_f32 v49, v49, v241
  v_mul_f32 v50, v50, v241
  v_mul_f32 v51, v51, v241
  v_mul_f32 v52, v52, v241
  v_mul_f32 v53, v53, v241
  v_mul_f32 v54, v54, v241
  v_mul_f32 v55, v55, v241
  v_mul_f32 v56, v56, v241
  v_mul_f32 v57, v57, v241
  v_mul_f32 v58, v58, v241
  v_mul_f32 v59, v59, v241
  v_mul_f32 v60, v60, v241
  v_mul_f32 v61, v61, v241
  v_mul_f32 v62, v62, v241
  v_mul_f32 v63, v63, v241
  v_mul_f32 v64, v64, v241
  v_mul_f32 v65, v65, v241
  v_mul_f32 v66, v66, v241
  v_mul_f32 v67, v67, v241
  v_mul_f32 v68, v68, v241
  v_mul_f32 v69, v69, v241
  v_mul_f32 v70, v70, v241
  v_mul_f32 v71, v71, v241
  v_mul_f32 v72, v72, v241
  v_mul_f32 v73, v73, v241
  v_mul_f32 v74, v74, v241
  v_mul_f32 v75, v75, v241
  v_mul_f32 v76, v76, v241
  v_mul_f32 v77, v77, v241
  v_mul_f32 v78, v78, v241
  v_mul_f32 v79, v79, v241
  v_mul_f32 v80, v80, v241
  v_mul_f32 v81, v81, v241
  v_mul_f32 v82, v82, v241
  v_mul_f32 v83, v83, v241
  v_mul_f32 v84, v84, v241
  v_mul_f32 v85, v85, v241
  v_mul_f32 v86, v86, v241
  v_mul_f32 v87, v87, v241
  v_mul_f32 v88, v88, v241
  v_mul_f32 v89, v89, v241
  v_mul_f32 v90, v90, v241
  v_mul_f32 v91, v91, v241
  v_mul_f32 v92, v92, v241
  v_mul_f32 v93, v93, v241
  v_mul_f32 v94, v94, v241
  v_mul_f32 v95, v95, v241
  v_mul_f32 v96, v96, v241
  v_mul_f32 v97, v97, v241
  v_mul_f32 v98, v98, v241
  v_mul_f32 v99, v99, v241
  v_mul_f32 v100, v100, v241
  v_mul_f32 v101, v101, v241
  v_mul_f32 v102, v102, v241
  v_mul_f32 v103, v103, v241
  v_mul_f32 v104, v104, v241
  v_mul_f32 v105, v105, v241
  v_mul_f32 v106, v106, v241
  v_mul_f32 v107, v107, v241
  v_mul_f32 v108, v108, v241
  v_mul_f32 v109, v109, v241
  v_mul_f32 v110, v110, v241
  v_mul_f32 v111, v111, v241
L_norescale_1:
  v_fma_f32 v24, v24, s44, v20
  v_fma_f32 v25, v25, s44, v20
  v_fma_f32 v26, v26, s44, v20
  v_fma_f32 v27, v27, s44, v20
  v_fma_f32 v28, v28, s44, v20
  v_fma_f32 v29, v29, s44, v20
  v_fma_f32 v30, v30, s44, v20
  v_fma_f32 v31, v31, s44, v20
  v_exp_f32 v24, v24
  v_exp_f32 v25, v25
  v_exp_f32 v26, v26
  v_exp_f32 v27, v27
  v_exp_f32 v28, v28
  v_exp_f32 v29, v29
  v_exp_f32 v30, v30
  v_exp_f32 v31, v31
  s_nop 0
  v_add_f32 v240, v24, v25
  v_add_f32 v241, v26, v27
  v_add_f32 v242, v28, v29
  v_cvt_pk_bf16_f32 v32, v24, v25
  v_add_f32 v240, v240, v241
  v_add_f32 v241, v30, v31
  v_cvt_pk_bf16_f32 v33, v26, v27
  v_add_f32 v242, v242, v241
  v_cvt_pk_bf16_f32 v34, v28, v29
  v_add_f32 v240, v240, v242
  v_cvt_pk_bf16_f32 v35, v30, v31
  v_add_f32 v19, v19, v240
  s_waitcnt vmcnt(32)
  v_perm_b32 v36, v120, v112, s45
  v_perm_b32 v37, v136, v128, s45
  v_perm_b32 v38, v152, v144, s45
  v_perm_b32 v39, v168, v160, s45
  v_perm_b32 v40, v120, v112, s46
  v_perm_b32 v41, v136, v128, s46
  v_perm_b32 v42, v152, v144, s46
  v_perm_b32 v43, v168, v160, s46
  v_mfma_f32_16x16x32_bf16 v[48:51], v[36:39], v[32:35], v[48:51]
  v_perm_b32 v44, v121, v113, s45
  v_perm_b32 v45, v137, v129, s45
  v_perm_b32 v46, v153, v145, s45
  v_perm_b32 v47, v169, v161, s45
  v_mfma_f32_16x16x32_bf16 v[52:55], v[40:43], v[32:35], v[52:55]
  v_perm_b32 v36, v121, v113, s46
  v_perm_b32 v37, v137, v129, s46
  v_perm_b32 v38, v153, v145, s46
  v_perm_b32 v39, v169, v161, s46
  v_mfma_f32_16x16x32_bf16 v[56:59], v[44:47], v[32:35], v[56:59]
  v_perm_b32 v40, v122, v114, s45
  v_perm_b32 v41, v138, v130, s45
  v_perm_b32 v42, v154, v146, s45
  v_perm_b32 v43, v170, v162, s45
  v_mfma_f32_16x16x32_bf16 v[60:63], v[36:39], v[32:35], v[60:63]
  v_perm_b32 v44, v122, v114, s46
  v_perm_b32 v45, v138, v130, s46
  v_perm_b32 v46, v154, v146, s46
  v_perm_b32 v47, v170, v162, s46
  v_mfma_f32_16x16x32_bf16 v[64:67], v[40:43], v[32:35], v[64:67]
  v_perm_b32 v36, v123, v115, s45
  v_perm_b32 v37, v139, v131, s45
  v_perm_b32 v38, v155, v147, s45
  v_perm_b32 v39, v171, v163, s45
  v_mfma_f32_16x16x32_bf16 v[68:71], v[44:47], v[32:35], v[68:71]
  v_perm_b32 v40, v123, v115, s46
  v_perm_b32 v41, v139, v131, s46
  v_perm_b32 v42, v155, v147, s46
  v_perm_b32 v43, v171, v163, s46
  v_mfma_f32_16x16x32_bf16 v[72:75], v[36:39], v[32:35], v[72:75]
  v_perm_b32 v44, v124, v116, s45
  v_perm_b32 v45, v140, v132, s45
  v_perm_b32 v46, v156, v148, s45
  v_perm_b32 v47, v172, v164, s45
  v_mfma_f32_16x16x32_bf16 v[76:79], v[40:43], v[32:35], v[76:79]
  v_perm_b32 v36, v124, v116, s46
  v_perm_b32 v37, v140, v132, s46
  v_perm_b32 v38, v156, v148, s46
  v_perm_b32 v39, v172, v164, s46
  v_mfma_f32_16x16x32_bf16 v[80:83], v[44:47], v[32:35], v[80:83]
  v_perm_b32 v40, v125, v117, s45
  v_perm_b32 v41, v141, v133, s45
  v_perm_b32 v42, v157, v149, s45
  v_perm_b32 v43, v173, v165, s45
  v_mfma_f32_16x16x32_bf16 v[84:87], v[36:39], v[32:35], v[84:87]
  v_perm_b32 v44, v125, v117, s46
  v_perm_b32 v45, v141, v133, s46
  v_perm_b32 v46, v157, v149, s46
  v_perm_b32 v47, v173, v165, s46
  v_mfma_f32_16x16x32_bf16 v[88:91], v[40:43], v[32:35], v[88:91]
  v_perm_b32 v36, v126, v118, s45
  v_perm_b32 v37, v142, v134, s45
  v_perm_b32 v38, v158, v150, s45
  v_perm_b32 v39, v174, v166, s45
  v_mfma_f32_16x16x32_bf16 v[92:95], v[44:47], v[32:35], v[92:95]
  v_perm_b32 v40, v126, v118, s46
  v_perm_b32 v41, v142, v134, s46
  v_perm_b32 v42, v158, v150, s46
  v_perm_b32 v43, v174, v166, s46
  v_mfma_f32_16x16x32_bf16 v[96:99], v[36:39], v[32:35], v[96:99]
  v_perm_b32 v44, v127, v119, s45
  v_perm_b32 v45, v143, v135, s45
  v_perm_b32 v46, v159, v151, s45
  v_perm_b32 v47, v175, v167, s45
  v_mfma_f32_16x16x32_bf16 v[100:103], v[40:43], v[32:35], v[100:103]
  v_perm_b32 v36, v127, v119, s46
  v_perm_b32 v37, v143, v135, s46
  v_perm_b32 v38, v159, v151, s46
  v_perm_b32 v39, v175, v167, s46
  v_mfma_f32_16x16x32_bf16 v[104:107], v[44:47], v[32:35], v[104:107]
  s_nop 1
  v_mfma_f32_16x16x32_bf16 v[108:111], v[36:39], v[32:35], v[108:111]
  ds_add_rtn_u32 v243, v21, v17
  s_waitcnt vmcnt(16)
  ds_read_b128 a[0:3], v13 offset:16384
  ds_read_b128 a[4:7], v13 offset:24576
  ds_read_b128 a[8:11], v14 offset:16384
  ds_read_b128 a[12:15], v14 offset:24576
  ds_read_b128 a[16:19], v15 offset:16384
  ds_read_b128 a[20:23], v15 offset:24576
  ds_read_b128 a[24:27], v16 offset:16384
  ds_read_b128 a[28:31], v16 offset:24576
  ds_read_b128 a[32:35], v13 offset:16640
  ds_read_b128 a[36:39], v13 offset:24832
  ds_read_b128 a[40:43], v14 offset:16640
  ds_read_b128 a[44:47], v14 offset:24832
  s_waitcnt lgkmcnt(8)
  v_mfma_f32_16x16x32_bf16 v[24:27], a[0:3], a[64:67], 0
  v_mfma_f32_16x16x32_bf16 v[28:31], a[4:7], a[64:67], 0
  v_mfma_f32_16x16x32_bf16 v[24:27], a[8:11], a[68:71], v[24:27]
  v_mfma_f32_16x16x32_bf16 v[28:31], a[12:15], a[68:71], v[28:31]
  ds_read_b128 a[48:51], v15 offset:16640
  ds_read_b128 a[52:55], v15 offset:24832
  ds_read_b128 a[56:59], v16 offset:16640
  ds_read_b128 a[60:63], v16 offset:24832
  s_waitcnt lgkmcnt(8)
  v_mfma_f32_16x16x32_bf16 v[24:27], a[16:19], a[72:75], v[24:27]
  v_mfma_f32_16x16x32_bf16 v[28:31], a[20:23], a[72:75], v[28:31]
  v_mfma_f32_16x16x32_bf16 v[24:27], a[24:27], a[76:79], v[24:27]
  v_mfma_f32_16x16x32_bf16 v[28:31], a[28:31], a[76:79], v[28:31]
  s_waitcnt lgkmcnt(4)
  v_mfma_f32_16x16x32_bf16 v[24:27], a[32:35], a[80:83], v[24:27]
  v_mfma_f32_16x16x32_bf16 v[28:31], a[36:39], a[80:83], v[28:31]
  v_mfma_f32_16x16x32_bf16 v[24:27], a[40:43], a[84:87], v[24:27]
  v_mfma_f32_16x16x32_bf16 v[28:31], a[44:47], a[84:87], v[28:31]
  s_waitcnt lgkmcnt(0)
  v_mfma_f32_16x16x32_bf16 v[24:27], a[48:51], a[88:91], v[24:27]
  v_mfma_f32_16x16x32_bf16 v[28:31], a[52:55], a[88:91], v[28:31]
  v_mfma_f32_16x16x32_bf16 v[24:27], a[56:59], a[92:95], v[24:27]
  v_mfma_f32_16x16x32_bf16 v[28:31], a[60:63], a[92:95], v[28:31]
  v_readfirstlane_b32 s41, v243
  s_nop 7
  v_cvt_pk_bf16_f32 v32, v24, v25
  v_cvt_pk_bf16_f32 v33, v26, v27
  v_cvt_pk_bf16_f32 v34, v28, v29
  v_cvt_pk_bf16_f32 v35, v30, v31
  v_lshlrev_b32 v24, 16, v32
  v_and_b32 v25, 0xffff0000, v32
  v_lshlrev_b32 v26, 16, v33
  v_and_b32 v27, 0xffff0000, v33
  v_lshlrev_b32 v28, 16, v34
  v_and_b32 v29, 0xffff0000, v34
  v_lshlrev_b32 v30, 16, v35
  v_and_b32 v31, 0xffff0000, v35
  v_max3_f32 v240, v24, v25, v26
  v_max3_f32 v241, v27, v28, v29
  v_max3_f32 v240, v30, v31, v240
  v_max_f32 v240, v240, v241
  v_mov_b32 v241, v240
  s_nop 1
  v_permlane16_swap_b32 v241, v240
  v_max_f32 v240, v240, v241
  v_mov_b32 v241, v240
  s_nop 1
  v_permlane32_swap_b32 v241, v240
  v_max3_f32 v240, v240, v241, v18
  v_cmp_gt_f32 vcc, v240, v18
  s_cbranch_vccz L_norescale_2
  v_sub_f32 v241, v18, v240
  v_mul_f32 v241, s44, v241
  v_exp_f32 v241, v241
  v_mov_b32 v18, v240
  v_mul_f32 v20, s44, v240
  v_mul_f32 v19, v19, v241
  v_sub_f32 v20, 0, v20
  v_mul_f32 v48, v48, v241
  v_mul_f32 v49, v49, v241
  v_mul_f32 v50, v50, v241
  v_mul_f32 v51, v51, v241
  v_mul_f32 v52, v52, v241
  v_mul_f32 v53, v53, v241
  v_mul_f32 v54, v54, v241
  v_mul_f32 v55, v55, v241
  v_mul_f32 v56, v56, v241
  v_mul_f32 v57, v57, v241
  v_mul_f32 v58, v58, v241
  v_mul_f32 v59, v59, v241
  v_mul_f32 v60, v60, v241
  v_mul_f32 v61, v61, v241
  v_mul_f32 v62, v62, v241
  v_mul_f32 v63, v63, v241
  v_mul_f32 v64, v64, v241
  v_mul_f32 v65, v65, v241
  v_mul_f32 v66, v66, v241
  v_mul_f32 v67, v67, v241
  v_mul_f32 v68, v68, v241
  v_mul_f32 v69, v69, v241
  v_mul_f32 v70, v70, v241
  v_mul_f32 v71, v71, v241
  v_mul_f32 v72, v72, v241
  v_mul_f32 v73, v73, v241
  v_mul_f32 v74, v74, v241
  v_mul_f32 v75, v75, v241
  v_mul_f32 v76, v76, v241
  v_mul_f32 v77, v77, v241
  v_mul_f32 v78, v78, v241
  v_mul_f32 v79, v79, v241
  v_mul_f32 v80, v80, v241
  v_mul_f32 v81, v81, v241
  v_mul_f32 v82, v82, v241
  v_mul_f32 v83, v83, v241
  v_mul_f32 v84, v84, v241
  v_mul_f32 v85, v85, v241
  v_mul_f32 v86, v86, v241
  v_mul_f32 v87, v87, v241
  v_mul_f32 v88, v88, v241
  v_mul_f32 v89, v89, v241
  v_mul_f32 v90, v90, v241
  v_mul_f32 v91, v91, v241
  v_mul_f32 v92, v92, v241
  v_mul_f32 v93, v93, v241
  v_mul_f32 v94, v94, v241
  v_mul_f32 v95, v95, v241
  v_mul_f32 v96, v96, v241
  v_mul_f32 v97, v97, v241
  v_mul_f32 v98, v98, v241
  v_mul_f32 v99, v99, v241
  v_mul_f32 v100, v100, v241
  v_mul_f32 v101, v101, v241
  v_mul_f32 v102, v102, v241
  v_mul_f32 v103, v103, v241
  v_mul_f32 v104, v104, v241
  v_mul_f32 v105, v105, v241
  v_mul_f32 v106, v106, v241
  v_mul_f32 v107, v107, v241
  v_mul_f32 v108, v108, v241
  v_mul_f32 v109, v109, v241
  v_mul_f32 v110, v110, v241
  v_mul_f32 v111, v111, v241
L_norescale_2:
  v_fma_f32 v24, v24, s44, v20
  v_fma_f32 v25, v25, s44, v20
  v_fma_f32 v26, v26, s44, v20
  v_fma_f32 v27, v27, s44, v20
  v_fma_f32 v28, v28, s44, v20
  v_fma_f32 v29, v29, s44, v20
  v_fma_f32 v30, v30, s44, v20
  v_fma_f32 v31, v31, s44, v20
  v_exp_f32 v24, v24
  v_exp_f32 v25, v25
  v_exp_f32 v26, v26
  v_exp_f32 v27, v27
  v_exp_f32 v28, v28
  v_exp_f32 v29, v29
  v_exp_f32 v30, v30
  v_exp_f32 v31, v31
  s_nop 0
  v_add_f32 v240, v24, v25
  v_add_f32 v241, v26, v27
  v_add_f32 v242, v28, v29
  v_cvt_pk_bf16_f32 v32, v24, v25
  v_add_f32 v240, v240, v241
  v_add_f32 v241, v30, v31
  v_cvt_pk_bf16_f32 v33, v26, v27
  v_add_f32 v242, v242, v241
  v_cvt_pk_bf16_f32 v34, v28, v29
  v_add_f32 v240, v240, v242
  v_cvt_pk_bf16_f32 v35, v30, v31
  v_add_f32 v19, v19, v240
  s_waitcnt vmcnt(0)
  s_cmp_ge_u32 s41, 128
  s_cbranch_scc1 L_nok_2
  s_lshl_b32 s40, s41, 14
  s_add_u32 s42, s40, 0
  s_add_u32 m0, s43, 0
  s_nop 0
  buffer_load_dwordx4 v4, s[32:35], s42 offen offset:0 nt lds
  buffer_load_dwordx4 v5, s[32:35], s42 offen offset:1024 nt lds
  buffer_load_dwordx4 v6, s[32:35], s42 offen offset:2048 nt lds
  buffer_load_dwordx4 v7, s[32:35], s42 offen offset:3072 nt lds
  s_add_u32 s42, s40, 4096
  s_add_u32 m0, s43, 4096
  s_nop 0
  buffer_load_dwordx4 v8, s[32:35], s42 offen offset:0 nt lds
  buffer_load_dwordx4 v9, s[32:35], s42 offen offset:1024 nt lds
  buffer_load_dwordx4 v10, s[32:35], s42 offen offset:2048 nt lds
  buffer_load_dwordx4 v11, s[32:35], s42 offen offset:3072 nt lds
  s_add_u32 s42, s40, 8192
  s_add_u32 m0, s43, 8192
  s_nop 0
  buffer_load_dwordx4 v4, s[32:35], s42 offen offset:0 nt lds
  buffer_load_dwordx4 v5, s[32:35], s42 offen offset:1024 nt lds
  buffer_load_dwordx4 v6, s[32:35], s42 offen offset:2048 nt lds
  buffer_load_dwordx4 v7, s[32:35], s42 offen offset:3072 nt lds
  s_add_u32 s42, s40, 12288
  s_add_u32 m0, s43, 12288
  s_nop 0
  buffer_load_dwordx4 v8, s[32:35], s42 offen offset:0 nt lds
  buffer_load_dwordx4 v9, s[32:35], s42 offen offset:1024 nt lds
  buffer_load_dwordx4 v10, s[32:35], s42 offen offset:2048 nt lds
  buffer_load_dwordx4 v11, s[32:35], s42 offen offset:3072 nt lds
  s_cmp_ge_u32 s41, 124
  s_cselect_b32 s71, 1, 0
  s_cbranch_scc0 L_nok_2
  s_add_u32 s42, s40, 0
  buffer_load_dwordx4 v[112:115], v12, s[36:39], s42 offen offset:0 nt
  buffer_load_dwordx4 v[116:119], v12, s[36:39], s42 offen offset:256 nt
  buffer_load_dwordx4 v[120:123], v12, s[36:39], s42 offen offset:2048 nt
  buffer_load_dwordx4 v[124:127], v12, s[36:39], s42 offen offset:2304 nt
  s_add_u32 s42, s40, 4096
  buffer_load_dwordx4 v[128:131], v12, s[36:39], s42 offen offset:0 nt
  buffer_load_dwordx4 v[132:135], v12, s[36:39], s42 offen offset:256 nt
  buffer_load_dwordx4 v[136:139], v12, s[36:39], s42 offen offset:2048 nt
  buffer_load_dwordx4 v[140:143], v12, s[36:39], s42 offen offset:2304 nt
  s_add_u32 s42, s40, 8192
  buffer_load_dwordx4 v[144:147], v12, s[36:39], s42 offen offset:0 nt
  buffer_load_dwordx4 v[148:151], v12, s[36:39], s42 offen offset:256 nt
  buffer_load_dwordx4 v[152:155], v12, s[36:39], s42 offen offset:2048 nt
  buffer_load_dwordx4 v[156:159], v12, s[36:39], s42 offen offset:2304 nt
  s_add_u32 s42, s40, 12288
  buffer_load_dwordx4 v[160:163], v12, s[36:39], s42 offen offset:0 nt
  buffer_load_dwordx4 v[164:167], v12, s[36:39], s42 offen offset:256 nt
  buffer_load_dwordx4 v[168:171], v12, s[36:39], s42 offen offset:2048 nt
  buffer_load_dwordx4 v[172:175], v12, s[36:39], s42 offen offset:2304 nt
L_nok_2:
  v_perm_b32 v36, v184, v176, s45
  v_perm_b32 v37, v200, v192, s45
  v_perm_b32 v38, v216, v208, s45
  v_perm_b32 v39, v232, v224, s45
  v_perm_b32 v40, v184, v176, s46
  v_perm_b32 v41, v200, v192, s46
  v_perm_b32 v42, v216, v208, s46
  v_perm_b32 v43, v232, v224, s46
  v_mfma_f32_16x16x32_bf16 v[48:51], v[36:39], v[32:35], v[48:51]
  v_perm_b32 v44, v185, v177, s45
  v_perm_b32 v45, v201, v193, s45
  v_perm_b32 v46, v217, v209, s45
  v_perm_b32 v47, v233, v225, s45
  v_mfma_f32_16x16x32_bf16 v[52:55], v[40:43], v[32:35], v[52:55]
  v_perm_b32 v36, v185, v177, s46
  v_perm_b32 v37, v201, v193, s46
  v_perm_b32 v38, v217, v209, s46
  v_perm_b32 v39, v233, v225, s46
  v_mfma_f32_16x16x32_bf16 v[56:59], v[44:47], v[32:35], v[56:59]
  v_perm_b32 v40, v186, v178, s45
  v_perm_b32 v41, v202, v194, s45
  v_perm_b32 v42, v218, v210, s45
  v_perm_b32 v43, v234, v226, s45
  v_mfma_f32_16x16x32_bf16 v[60:63], v[36:39], v[32:35], v[60:63]
  v_perm_b32 v44, v186, v178, s46
  v_perm_b32 v45, v202, v194, s46
  v_perm_b32 v46, v218, v210, s46
  v_perm_b32 v47, v234, v226, s46
  v_mfma_f32_16x16x32_bf16 v[64:67], v[40:43], v[32:35], v[64:67]
  v_perm_b32 v36, v187, v179, s45
  v_perm_b32 v37, v203, v195, s45
  v_perm_b32 v38, v219, v211, s45
  v_perm_b32 v39, v235, v227, s45
  v_mfma_f32_16x16x32_bf16 v[68:71], v[44:47], v[32:35], v[68:71]
  v_perm_b32 v40, v187, v179, s46
  v_perm_b32 v41, v203, v195, s46
  v_perm_b32 v42, v219, v211, s46
  v_perm_b32 v43, v235, v227, s46
  v_mfma_f32_16x16x32_bf16 v[72:75], v[36:39], v[32:35], v[72:75]
  v_perm_b32 v44, v188, v180, s45
  v_perm_b32 v45, v204, v196, s45
  v_perm_b32 v46, v220, v212, s45
  v_perm_b32 v47, v236, v228, s45
  v_mfma_f32_16x16x32_bf16 v[76:79], v[40:43], v[32:35], v[76:79]
  v_perm_b32 v36, v188, v180, s46
  v_perm_b32 v37, v204, v196, s46
  v_perm_b32 v38, v220, v212, s46
  v_perm_b32 v39, v236, v228, s46
  v_mfma_f32_16x16x32_bf16 v[80:83], v[44:47], v[32:35], v[80:83]
  v_perm_b32 v40, v189, v181, s45
  v_perm_b32 v41, v205, v197, s45
  v_perm_b32 v42, v221, v213, s45
  v_perm_b32 v43, v237, v229, s45
  v_mfma_f32_16x16x32_bf16 v[84:87], v[36:39], v[32:35], v[84:87]
  v_perm_b32 v44, v189, v181, s46
  v_perm_b32 v45, v205, v197, s46
  v_perm_b32 v46, v221, v213, s46
  v_perm_b32 v47, v237, v229, s46
  v_mfma_f32_16x16x32_bf16 v[88:91], v[40:43], v[32:35], v[88:91]
  v_perm_b32 v36, v190, v182, s45
  v_perm_b32 v37, v206, v198, s45
  v_perm_b32 v38, v222, v214, s45
  v_perm_b32 v39, v238, v230, s45
  v_mfma_f32_16x16x32_bf16 v[92:95], v[44:47], v[32:35], v[92:95]
  v_perm_b32 v40, v190, v182, s46
  v_perm_b32 v41, v206, v198, s46
  v_perm_b32 v42, v222, v214, s46
  v_perm_b32 v43, v238, v230, s46
  v_mfma_f32_16x16x32_bf16 v[96:99], v[36:39], v[32:35], v[96:99]
  v_perm_b32 v44, v191, v183, s45
  v_perm_b32 v45, v207, v199, s45
  v_perm_b32 v46, v223, v215, s45
  v_perm_b32 v47, v239, v231, s45
  v_mfma_f32_16x16x32_bf16 v[100:103], v[40:43], v[32:35], v[100:103]
  v_perm_b32 v36, v191, v183, s46
  v_perm_b32 v37, v207, v199, s46
  v_perm_b32 v38, v223, v215, s46
  v_perm_b32 v39, v239, v231, s46
  v_mfma_f32_16x16x32_bf16 v[104:107], v[44:47], v[32:35], v[104:107]
  s_nop 1
  v_mfma_f32_16x16x32_bf16 v[108:111], v[36:39], v[32:35], v[108:111]
  s_cmp_ge_u32 s41, 128
  s_cbranch_scc1 L_u_done
L_u_loop:
  ds_add_rtn_u32 v243, v21, v17
  s_cmp_eq_u32 s71, 0
  s_cbranch_scc1 L_ev0_3
  s_waitcnt vmcnt(16)
  s_branch L_ev1_3
L_ev0_3:
  s_waitcnt vmcnt(0)
  s_add_u32 s42, s40, 0
  buffer_load_dwordx4 v[112:115], v12, s[36:39], s42 offen offset:0 nt
  buffer_load_dwordx4 v[116:119], v12, s[36:39], s42 offen offset:256 nt
  buffer_load_dwordx4 v[120:123], v12, s[36:39], s42 offen offset:2048 nt
  buffer_load_dwordx4 v[124:127], v12, s[36:39], s42 offen offset:2304 nt
  s_add_u32 s42, s40, 4096
  buffer_load_dwordx4 v[128:131], v12, s[36:39], s42 offen offset:0 nt
  buffer_load_dwordx4 v[132:135], v12, s[36:39], s42 offen offset:256 nt
  buffer_load_dwordx4 v[136:139], v12, s[36:39], s42 offen offset:2048 nt
  buffer_load_dwordx4 v[140:143], v12, s[36:39], s42 offen offset:2304 nt
  s_add_u32 s42, s40, 8192
  buffer_load_dwordx4 v[144:147], v12, s[36:39], s42 offen offset:0 nt
  buffer_load_dwordx4 v[148:151], v12, s[36:39], s42 offen offset:256 nt
  buffer_load_dwordx4 v[152:155], v12, s[36:39], s42 offen offset:2048 nt
  buffer_load_dwordx4 v[156:159], v12, s[36:39], s42 offen offset:2304 nt
  s_add_u32 s42, s40, 12288
  buffer_load_dwordx4 v[160:163], v12, s[36:39], s42 offen offset:0 nt
  buffer_load_dwordx4 v[164:167], v12, s[36:39], s42 offen offset:256 nt
  buffer_load_dwordx4 v[168:171], v12, s[36:39], s42 offen offset:2048 nt
  buffer_load_dwordx4 v[172:175], v12, s[36:39], s42 offen offset:2304 nt
L_ev1_3:
  ds_read_b128 a[0:3], v13 offset:0
  ds_read_b128 a[4:7], v13 offset:8192
  ds_read_b128 a[8:11], v14 offset:0
  ds_read_b128 a[12:15], v14 offset:8192
  ds_read_b128 a[16:19], v15 offset:0
  ds_read_b128 a[20:23], v15 offset:8192
  ds_read_b128 a[24:27], v16 offset:0
  ds_read_b128 a[28:31], v16 offset:8192
  ds_read_b128 a[32:35], v13 offset:256
  ds_read_b128 a[36:39], v13 offset:8448
  ds_read_b128 a[40:43], v14 offset:256
  ds_read_b128 a[44:47], v14 offset:8448
  s_waitcnt lgkmcnt(8)
  v_mfma_f32_16x16x32_bf16 v[24:27], a[0:3], a[64:67], 0
  v_mfma_f32_16x16x32_bf16 v[28:31], a[4:7], a[64:67], 0
  v_mfma_f32_16x16x32_bf16 v[24:27], a[8:11], a[68:71], v[24:27]
  v_mfma_f32_16x16x32_bf16 v[28:31], a[12:15], a[68:71], v[28:31]
  ds_read_b128 a[48:51], v15 offset:256
  ds_read_b128 a[52:55], v15 offset:8448
  ds_read_b128 a[56:59], v16 offset:256
  ds_read_b128 a[60:63], v16 offset:8448
  s_waitcnt lgkmcnt(8)
  v_mfma_f32_16x16x32_bf16 v[24:27], a[16:19], a[72:75], v[24:27]
  v_mfma_f32_16x16x32_bf16 v[28:31], a[20:23], a[72:75], v[28:31]
  v_mfma_f32_16x16x32_bf16 v[24:27], a[24:27], a[76:79], v[24:27]
  v_mfma_f32_16x16x32_bf16 v[28:31], a[28:31], a[76:79], v[28:31]
  s_waitcnt lgkmcnt(4)
  v_mfma_f32_16x16x32_bf16 v[24:27], a[32:35], a[80:83], v[24:27]
  v_mfma_f32_16x16x32_bf16 v[28:31], a[36:39], a[80:83], v[28:31]
  v_mfma_f32_16x16x32_bf16 v[24:27], a[40:43], a[84:87], v[24:27]
  v_mfma_f32_16x16x32_bf16 v[28:31], a[44:47], a[84:87], v[28:31]
  s_waitcnt lgkmcnt(0)
  v_mfma_f32_16x16x32_bf16 v[24:27], a[48:51], a[88:91], v[24:27]
  v_mfma_f32_16x16x32_bf16 v[28:31], a[52:55], a[88:91], v[28:31]
  v_mfma_f32_16x16x32_bf16 v[24:27], a[56:59], a[92:95], v[24:27]
  v_mfma_f32_16x16x32_bf16 v[28:31], a[60:63], a[92:95], v[28:31]
  v_readfirstlane_b32 s41, v243
  s_nop 7
  v_cvt_pk_bf16_f32 v32, v24, v25
  v_cvt_pk_bf16_f32 v33, v26, v27
  v_cvt_pk_bf16_f32 v34, v28, v29
  v_cvt_pk_bf16_f32 v35, v30, v31
  v_lshlrev_b32 v24, 16, v32
  v_and_b32 v25, 0xffff0000, v32
  v_lshlrev_b32 v26, 16, v33
  v_and_b32 v27, 0xffff0000, v33
  v_lshlrev_b32 v28, 16, v34
  v_and_b32 v29, 0xffff0000, v34
  v_lshlrev_b32 v30, 16, v35
  v_and_b32 v31, 0xffff0000, v35
  v_max3_f32 v240, v24, v25, v26
  v_max3_f32 v241, v27, v28, v29
  v_max3_f32 v240, v30, v31, v240
  v_max_f32 v240, v240, v241
  v_mov_b32 v241, v240
  s_nop 1
  v_permlane16_swap_b32 v241, v240
  v_max_f32 v240, v240, v241
  v_mov_b32 v241, v240
  s_nop 1
  v_permlane32_swap_b32 v241, v240
  v_max3_f32 v240, v240, v241, v18
  v_cmp_gt_f32 vcc, v240, v18
  s_cbranch_vccz L_norescale_3
  v_sub_f32 v241, v18, v240
  v_mul_f32 v241, s44, v241
  v_exp_f32 v241, v241
  v_mov_b32 v18, v240
  v_mul_f32 v20, s44, v240
  v_mul_f32 v19, v19, v241
  v_sub_f32 v20, 0, v20
  v_mul_f32 v48, v48, v241
  v_mul_f32 v49, v49, v241
  v_mul_f32 v50, v50, v241
  v_mul_f32 v51, v51, v241
  v_mul_f32 v52, v52, v241
  v_mul_f32 v53, v53, v241
  v_mul_f32 v54, v54, v241
  v_mul_f32 v55, v55, v241
  v_mul_f32 v56, v56, v241
  v_mul_f32 v57, v57, v241
  v_mul_f32 v58, v58, v241
  v_mul_f32 v59, v59, v241
  v_mul_f32 v60, v60, v241
  v_mul_f32 v61, v61, v241
  v_mul_f32 v62, v62, v241
  v_mul_f32 v63, v63, v241
  v_mul_f32 v64, v64, v241
  v_mul_f32 v65, v65, v241
  v_mul_f32 v66, v66, v241
  v_mul_f32 v67, v67, v241
  v_mul_f32 v68, v68, v241
  v_mul_f32 v69, v69, v241
  v_mul_f32 v70, v70, v241
  v_mul_f32 v71, v71, v241
  v_mul_f32 v72, v72, v241
  v_mul_f32 v73, v73, v241
  v_mul_f32 v74, v74, v241
  v_mul_f32 v75, v75, v241
  v_mul_f32 v76, v76, v241
  v_mul_f32 v77, v77, v241
  v_mul_f32 v78, v78, v241
  v_mul_f32 v79, v79, v241
  v_mul_f32 v80, v80, v241
  v_mul_f32 v81, v81, v241
  v_mul_f32 v82, v82, v241
  v_mul_f32 v83, v83, v241
  v_mul_f32 v84, v84, v241
  v_mul_f32 v85, v85, v241
  v_mul_f32 v86, v86, v241
  v_mul_f32 v87, v87, v241
  v_mul_f32 v88, v88, v241
  v_mul_f32 v89, v89, v241
  v_mul_f32 v90, v90, v241
  v_mul_f32 v91, v91, v241
  v_mul_f32 v92, v92, v241
  v_mul_f32 v93, v93, v241
  v_mul_f32 v94, v94, v241
  v_mul_f32 v95, v95, v241
  v_mul_f32 v96, v96, v241
  v_mul_f32 v97, v97, v241
  v_mul_f32 v98, v98, v241
  v_mul_f32 v99, v99, v241
  v_mul_f32 v100, v100, v241
  v_mul_f32 v101, v101, v241
  v_mul_f32 v102, v102, v241
  v_mul_f32 v103, v103, v241
  v_mul_f32 v104, v104, v241
  v_mul_f32 v105, v105, v241
  v_mul_f32 v106, v106, v241
  v_mul_f32 v107, v107, v241
  v_mul_f32 v108, v108, v241
  v_mul_f32 v109, v109, v241
  v_mul_f32 v110, v110, v241
  v_mul_f32 v111, v111, v241
L_norescale_3:
  v_fma_f32 v24, v24, s44, v20
  v_fma_f32 v25, v25, s44, v20
  v_fma_f32 v26, v26, s44, v20
  v_fma_f32 v27, v27, s44, v20
  v_fma_f32 v28, v28, s44, v20
  v_fma_f32 v29, v29, s44, v20
  v_fma_f32 v30, v30, s44, v20
  v_fma_f32 v31, v31, s44, v20
  v_exp_f32 v24, v24
  v_exp_f32 v25, v25
  v_exp_f32 v26, v26
  v_exp_f32 v27, v27
  v_exp_f32 v28, v28
  v_exp_f32 v29, v29
  v_exp_f32 v30, v30
  v_exp_f32 v31, v31
  s_nop 0
  v_add_f32 v240, v24, v25
  v_add_f32 v241, v26, v27
  v_add_f32 v242, v28, v29
  v_cvt_pk_bf16_f32 v32, v24, v25
  v_add_f32 v240, v240, v241
  v_add_f32 v241, v30, v31
  v_cvt_pk_bf16_f32 v33, v26, v27
  v_add_f32 v242, v242, v241
  v_cvt_pk_bf16_f32 v34, v28, v29
  v_add_f32 v240, v240, v242
  v_cvt_pk_bf16_f32 v35, v30, v31
  v_add_f32 v19, v19, v240
  s_waitcnt vmcnt(0)
  s_cmp_ge_u32 s41, 128
  s_cbranch_scc1 L_nok_3
  s_lshl_b32 s40, s41, 14
  s_add_u32 s42, s40, 0
  s_add_u32 m0, s43, 16384
  s_nop 0
  buffer_load_dwordx4 v4, s[32:35], s42 offen offset:0 nt lds
  buffer_load_dwordx4 v5, s[32:35], s42 offen offset:1024 nt lds
  buffer_load_dwordx4 v6, s[32:35], s42 offen offset:2048 nt lds
  buffer_load_dwordx4 v7, s[32:35], s42 offen offset:3072 nt lds
  s_add_u32 s42, s40, 4096
  s_add_u32 m0, s43, 20480
  s_nop 0
  buffer_load_dwordx4 v8, s[32:35], s42 offen offset:0 nt lds
  buffer_load_dwordx4 v9, s[32:35], s42 offen offset:1024 nt lds
  buffer_load_dwordx4 v10, s[32:35], s42 offen offset:2048 nt lds
  buffer_load_dwordx4 v11, s[32:35], s42 offen offset:3072 nt lds
  s_add_u32 s42, s40, 8192
  s_add_u32 m0, s43, 24576
  s_nop 0
  buffer_load_dwordx4 v4, s[32:35], s42 offen offset:0 nt lds
  buffer_load_dwordx4 v5, s[32:35], s42 offen offset:1024 nt lds
  buffer_load_dwordx4 v6, s[32:35], s42 offen offset:2048 nt lds
  buffer_load_dwordx4 v7, s[32:35], s42 offen offset:3072 nt lds
  s_add_u32 s42, s40, 12288
  s_add_u32 m0, s43, 28672
  s_nop 0
  buffer_load_dwordx4 v8, s[32:35], s42 offen offset:0 nt lds
  buffer_load_dwordx4 v9, s[32:35], s42 offen offset:1024 nt lds
  buffer_load_dwordx4 v10, s[32:35], s42 offen offset:2048 nt lds
  buffer_load_dwordx4 v11, s[32:35], s42 offen offset:3072 nt lds
  s_cmp_ge_u32 s41, 124
  s_cselect_b32 s71, 1, 0
  s_cbranch_scc0 L_nok_3
  s_add_u32 s42, s40, 0
  buffer_load_dwordx4 v[176:179], v12, s[36:39], s42 offen offset:0 nt
  buffer_load_dwordx4 v[180:183], v12, s[36:39], s42 offen offset:256 nt
  buffer_load_dwordx4 v[184:187], v12, s[36:39], s42 offen offset:2048 nt
  buffer_load_dwordx4 v[188:191], v12, s[36:39], s42 offen offset:2304 nt
  s_add_u32 s42, s40, 4096
  buffer_load_dwordx4 v[192:195], v12, s[36:39], s42 offen offset:0 nt
  buffer_load_dwordx4 v[196:199], v12, s[36:39], s42 offen offset:256 nt
  buffer_load_dwordx4 v[200:203], v12, s[36:39], s42 offen offset:2048 nt
  buffer_load_dwordx4 v[204:207], v12, s[36:39], s42 offen offset:2304 nt
  s_add_u32 s42, s40, 8192
  buffer_load_dwordx4 v[208:211], v12, s[36:39], s42 offen offset:0 nt
  buffer_load_dwordx4 v[212:215], v12, s[36:39], s42 offen offset:256 nt
  buffer_load_dwordx4 v[216:219], v12, s[36:39], s42 offen offset:2048 nt
  buffer_load_dwordx4 v[220:223], v12, s[36:39], s42 offen offset:2304 nt
  s_add_u32 s42, s40, 12288
  buffer_load_dwordx4 v[224:227], v12, s[36:39], s42 offen offset:0 nt
  buffer_load_dwordx4 v[228:231], v12, s[36:39], s42 offen offset:256 nt
  buffer_load_dwordx4 v[232:235], v12, s[36:39], s42 offen offset:2048 nt
  buffer_load_dwordx4 v[236:239], v12, s[36:39], s42 offen offset:2304 nt
L_nok_3:
  v_perm_b32 v36, v120, v112, s45
  v_perm_b32 v37, v136, v128, s45
  v_perm_b32 v38, v152, v144, s45
  v_perm_b32 v39, v168, v160, s45
  v_perm_b32 v40, v120, v112, s46
  v_perm_b32 v41, v136, v128, s46
  v_perm_b32 v42, v152, v144, s46
  v_perm_b32 v43, v168, v160, s46
  v_mfma_f32_16x16x32_bf16 v[48:51], v[36:39], v[32:35], v[48:51]
  v_perm_b32 v44, v121, v113, s45
  v_perm_b32 v45, v137, v129, s45
  v_perm_b32 v46, v153, v145, s45
  v_perm_b32 v47, v169, v161, s45
  v_mfma_f32_16x16x32_bf16 v[52:55], v[40:43], v[32:35], v[52:55]
  v_perm_b32 v36, v121, v113, s46
  v_perm_b32 v37, v137, v129, s46
  v_perm_b32 v38, v153, v145, s46
  v_perm_b32 v39, v169, v161, s46
  v_mfma_f32_16x16x32_bf16 v[56:59], v[44:47], v[32:35], v[56:59]
  v_perm_b32 v40, v122, v114, s45
  v_perm_b32 v41, v138, v130, s45
  v_perm_b32 v42, v154, v146, s45
  v_perm_b32 v43, v170, v162, s45
  v_mfma_f32_16x16x32_bf16 v[60:63], v[36:39], v[32:35], v[60:63]
  v_perm_b32 v44, v122, v114, s46
  v_perm_b32 v45, v138, v130, s46
  v_perm_b32 v46, v154, v146, s46
  v_perm_b32 v47, v170, v162, s46
  v_mfma_f32_16x16x32_bf16 v[64:67], v[40:43], v[32:35], v[64:67]
  v_perm_b32 v36, v123, v115, s45
  v_perm_b32 v37, v139, v131, s45
  v_perm_b32 v38, v155, v147, s45
  v_perm_b32 v39, v171, v163, s45
  v_mfma_f32_16x16x32_bf16 v[68:71], v[44:47], v[32:35], v[68:71]
  v_perm_b32 v40, v123, v115, s46
  v_perm_b32 v41, v139, v131, s46
  v_perm_b32 v42, v155, v147, s46
  v_perm_b32 v43, v171, v163, s46
  v_mfma_f32_16x16x32_bf16 v[72:75], v[36:39], v[32:35], v[72:75]
  v_perm_b32 v44, v124, v116, s45
  v_perm_b32 v45, v140, v132, s45
  v_perm_b32 v46, v156, v148, s45
  v_perm_b32 v47, v172, v164, s45
  v_mfma_f32_16x16x32_bf16 v[76:79], v[40:43], v[32:35], v[76:79]
  v_perm_b32 v36, v124, v116, s46
  v_perm_b32 v37, v140, v132, s46
  v_perm_b32 v38, v156, v148, s46
  v_perm_b32 v39, v172, v164, s46
  v_mfma_f32_16x16x32_bf16 v[80:83], v[44:47], v[32:35], v[80:83]
  v_perm_b32 v40, v125, v117, s45
  v_perm_b32 v41, v141, v133, s45
  v_perm_b32 v42, v157, v149, s45
  v_perm_b32 v43, v173, v165, s45
  v_mfma_f32_16x16x32_bf16 v[84:87], v[36:39], v[32:35], v[84:87]
  v_perm_b32 v44, v125, v117, s46
  v_perm_b32 v45, v141, v133, s46
  v_perm_b32 v46, v157, v149, s46
  v_perm_b32 v47, v173, v165, s46
  v_mfma_f32_16x16x32_bf16 v[88:91], v[40:43], v[32:35], v[88:91]
  v_perm_b32 v36, v126, v118, s45
  v_perm_b32 v37, v142, v134, s45
  v_perm_b32 v38, v158, v150, s45
  v_perm_b32 v39, v174, v166, s45
  v_mfma_f32_16x16x32_bf16 v[92:95], v[44:47], v[32:35], v[92:95]
  v_perm_b32 v40, v126, v118, s46
  v_perm_b32 v41, v142, v134, s46
  v_perm_b32 v42, v158, v150, s46
  v_perm_b32 v43, v174, v166, s46
  v_mfma_f32_16x16x32_bf16 v[96:99], v[36:39], v[32:35], v[96:99]
  v_perm_b32 v44, v127, v119, s45
  v_perm_b32 v45, v143, v135, s45
  v_perm_b32 v46, v159, v151, s45
  v_perm_b32 v47, v175, v167, s45
  v_mfma_f32_16x16x32_bf16 v[100:103], v[40:43], v[32:35], v[100:103]
  v_perm_b32 v36, v127, v119, s46
  v_perm_b32 v37, v143, v135, s46
  v_perm_b32 v38, v159, v151, s46
  v_perm_b32 v39, v175, v167, s46
  v_mfma_f32_16x16x32_bf16 v[104:107], v[44:47], v[32:35], v[104:107]
  s_nop 1
  v_mfma_f32_16x16x32_bf16 v[108:111], v[36:39], v[32:35], v[108:111]
  s_cmp_ge_u32 s41, 128
  s_cbranch_scc1 L_u_done
  ds_add_rtn_u32 v243, v21, v17
  s_cmp_eq_u32 s71, 0
  s_cbranch_scc1 L_ev0_4
  s_waitcnt vmcnt(16)
  s_branch L_ev1_4
L_ev0_4:
  s_waitcnt vmcnt(0)
  s_add_u32 s42, s40, 0
  buffer_load_dwordx4 v[176:179], v12, s[36:39], s42 offen offset:0 nt
  buffer_load_dwordx4 v[180:183], v12, s[36:39], s42 offen offset:256 nt
  buffer_load_dwordx4 v[184:187], v12, s[36:39], s42 offen offset:2048 nt
  buffer_load_dwordx4 v[188:191], v12, s[36:39], s42 offen offset:2304 nt
  s_add_u32 s42, s40, 4096
  buffer_load_dwordx4 v[192:195], v12, s[36:39], s42 offen offset:0 nt
  buffer_load_dwordx4 v[196:199], v12, s[36:39], s42 offen offset:256 nt
  buffer_load_dwordx4 v[200:203], v12, s[36:39], s42 offen offset:2048 nt
  buffer_load_dwordx4 v[204:207], v12, s[36:39], s42 offen offset:2304 nt
  s_add_u32 s42, s40, 8192
  buffer_load_dwordx4 v[208:211], v12, s[36:39], s42 offen offset:0 nt
  buffer_load_dwordx4 v[212:215], v12, s[36:39], s42 offen offset:256 nt
  buffer_load_dwordx4 v[216:219], v12, s[36:39], s42 offen offset:2048 nt
  buffer_load_dwordx4 v[220:223], v12, s[36:39], s42 offen offset:2304 nt
  s_add_u32 s42, s40, 12288
  buffer_load_dwordx4 v[224:227], v12, s[36:39], s42 offen offset:0 nt
  buffer_load_dwordx4 v[228:231], v12, s[36:39], s42 offen offset:256 nt
  buffer_load_dwordx4 v[232:235], v12, s[36:39], s42 offen offset:2048 nt
  buffer_load_dwordx4 v[236:239], v12, s[36:39], s42 offen offset:2304 nt
L_ev1_4:
  ds_read_b128 a[0:3], v13 offset:16384
  ds_read_b128 a[4:7], v13 offset:24576
  ds_read_b128 a[8:11], v14 offset:16384
  ds_read_b128 a[12:15], v14 offset:24576
  ds_read_b128 a[16:19], v15 offset:16384
  ds_read_b128 a[20:23], v15 offset:24576
  ds_read_b128 a[24:27], v16 offset:16384
  ds_read_b128 a[28:31], v16 offset:24576
  ds_read_b128 a[32:35], v13 offset:16640
  ds_read_b128 a[36:39], v13 offset:24832
  ds_read_b128 a[40:43], v14 offset:16640
  ds_read_b128 a[44:47], v14 offset:24832
  s_waitcnt lgkmcnt(8)
  v_mfma_f32_16x16x32_bf16 v[24:27], a[0:3], a[64:67], 0
  v_mfma_f32_16x16x32_bf16 v[28:31], a[4:7], a[64:67], 0
  v_mfma_f32_16x16x32_bf16 v[24:27], a[8:11], a[68:71], v[24:27]
  v_mfma_f32_16x16x32_bf16 v[28:31], a[12:15], a[68:71], v[28:31]
  ds_read_b128 a[48:51], v15 offset:16640
  ds_read_b128 a[52:55], v15 offset:24832
  ds_read_b128 a[56:59], v16 offset:16640
  ds_read_b128 a[60:63], v16 offset:24832
  s_waitcnt lgkmcnt(8)
  v_mfma_f32_16x16x32_bf16 v[24:27], a[16:19], a[72:75], v[24:27]
  v_mfma_f32_16x16x32_bf16 v[28:31], a[20:23], a[72:75], v[28:31]
  v_mfma_f32_16x16x32_bf16 v[24:27], a[24:27], a[76:79], v[24:27]
  v_mfma_f32_16x16x32_bf16 v[28:31], a[28:31], a[76:79], v[28:31]
  s_waitcnt lgkmcnt(4)
  v_mfma_f32_16x16x32_bf16 v[24:27], a[32:35], a[80:83], v[24:27]
  v_mfma_f32_16x16x32_bf16 v[28:31], a[36:39], a[80:83], v[28:31]
  v_mfma_f32_16x16x32_bf16 v[24:27], a[40:43], a[84:87], v[24:27]
  v_mfma_f32_16x16x32_bf16 v[28:31], a[44:47], a[84:87], v[28:31]
  s_waitcnt lgkmcnt(0)
  v_mfma_f32_16x16x32_bf16 v[24:27], a[48:51], a[88:91], v[24:27]
  v_mfma_f32_16x16x32_bf16 v[28:31], a[52:55], a[88:91], v[28:31]
  v_mfma_f32_16x16x32_bf16 v[24:27], a[56:59], a[92:95], v[24:27]
  v_mfma_f32_16x16x32_bf16 v[28:31], a[60:63], a[92:95], v[28:31]
  v_readfirstlane_b32 s41, v243
  s_nop 7
  v_cvt_pk_bf16_f32 v32, v24, v25
  v_cvt_pk_bf16_f32 v33, v26, v27
  v_cvt_pk_bf16_f32 v34, v28, v29
  v_cvt_pk_bf16_f32 v35, v30, v31
  v_lshlrev_b32 v24, 16, v32
  v_and_b32 v25, 0xffff0000, v32
  v_lshlrev_b32 v26, 16, v33
  v_and_b32 v27, 0xffff0000, v33
  v_lshlrev_b32 v28, 16, v34
  v_and_b32 v29, 0xffff0000, v34
  v_lshlrev_b32 v30, 16, v35
  v_and_b32 v31, 0xffff0000, v35
  v_max3_f32 v240, v24, v25, v26
  v_max3_f32 v241, v27, v28, v29
  v_max3_f32 v240, v30, v31, v240
  v_max_f32 v240, v240, v241
  v_mov_b32 v241, v240
  s_nop 1
  v_permlane16_swap_b32 v241, v240
  v_max_f32 v240, v240, v241
  v_mov_b32 v241, v240
  s_nop 1
  v_permlane32_swap_b32 v241, v240
  v_max3_f32 v240, v240, v241, v18
  v_cmp_gt_f32 vcc, v240, v18
  s_cbranch_vccz L_norescale_4
  v_sub_f32 v241, v18, v240
  v_mul_f32 v241, s44, v241
  v_exp_f32 v241, v241
  v_mov_b32 v18, v240
  v_mul_f32 v20, s44, v240
  v_mul_f32 v19, v19, v241
  v_sub_f32 v20, 0, v20
  v_mul_f32 v48, v48, v241
  v_mul_f32 v49, v49, v241
  v_mul_f32 v50, v50, v241
  v_mul_f32 v51, v51, v241
  v_mul_f32 v52, v52, v241
  v_mul_f32 v53, v53, v241
  v_mul_f32 v54, v54, v241
  v_mul_f32 v55, v55, v241
  v_mul_f32 v56, v56, v241
  v_mul_f32 v57, v57, v241
  v_mul_f32 v58, v58, v241
  v_mul_f32 v59, v59, v241
  v_mul_f32 v60, v60, v241
  v_mul_f32 v61, v61, v241
  v_mul_f32 v62, v62, v241
  v_mul_f32 v63, v63, v241
  v_mul_f32 v64, v64, v241
  v_mul_f32 v65, v65, v241
  v_mul_f32 v66, v66, v241
  v_mul_f32 v67, v67, v241
  v_mul_f32 v68, v68, v241
  v_mul_f32 v69, v69, v241
  v_mul_f32 v70, v70, v241
  v_mul_f32 v71, v71, v241
  v_mul_f32 v72, v72, v241
  v_mul_f32 v73, v73, v241
  v_mul_f32 v74, v74, v241
  v_mul_f32 v75, v75, v241
  v_mul_f32 v76, v76, v241
  v_mul_f32 v77, v77, v241
  v_mul_f32 v78, v78, v241
  v_mul_f32 v79, v79, v241
  v_mul_f32 v80, v80, v241
  v_mul_f32 v81, v81, v241
  v_mul_f32 v82, v82, v241
  v_mul_f32 v83, v83, v241
  v_mul_f32 v84, v84, v241
  v_mul_f32 v85, v85, v241
  v_mul_f32 v86, v86, v241
  v_mul_f32 v87, v87, v241
  v_mul_f32 v88, v88, v241
  v_mul_f32 v89, v89, v241
  v_mul_f32 v90, v90, v241
  v_mul_f32 v91, v91, v241
  v_mul_f32 v92, v92, v241
  v_mul_f32 v93, v93, v241
  v_mul_f32 v94, v94, v241
  v_mul_f32 v95, v95, v241
  v_mul_f32 v96, v96, v241
  v_mul_f32 v97, v97, v241
  v_mul_f32 v98, v98, v241
  v_mul_f32 v99, v99, v241
  v_mul_f32 v100, v100, v241
  v_mul_f32 v101, v101, v241
  v_mul_f32 v102, v102, v241
  v_mul_f32 v103, v103, v241
  v_mul_f32 v104, v104, v241
  v_mul_f32 v105, v105, v241
  v_mul_f32 v106, v106, v241
  v_mul_f32 v107, v107, v241
  v_mul_f32 v108, v108, v241
  v_mul_f32 v109, v109, v241
  v_mul_f32 v110, v110, v241
  v_mul_f32 v111, v111, v241
L_norescale_4:
  v_fma_f32 v24, v24, s44, v20
  v_fma_f32 v25, v25, s44, v20
  v_fma_f32 v26, v26, s44, v20
  v_fma_f32 v27, v27, s44, v20
  v_fma_f32 v28, v28, s44, v20
  v_fma_f32 v29, v29, s44, v20
  v_fma_f32 v30, v30, s44, v20
  v_fma_f32 v31, v31, s44, v20
  v_exp_f32 v24, v24
  v_exp_f32 v25, v25
  v_exp_f32 v26, v26
  v_exp_f32 v27, v27
  v_exp_f32 v28, v28
  v_exp_f32 v29, v29
  v_exp_f32 v30, v30
  v_exp_f32 v31, v31
  s_nop 0
  v_add_f32 v240, v24, v25
  v_add_f32 v241, v26, v27
  v_add_f32 v242, v28, v29
  v_cvt_pk_bf16_f32 v32, v24, v25
  v_add_f32 v240, v240, v241
  v_add_f32 v241, v30, v31
  v_cvt_pk_bf16_f32 v33, v26, v27
  v_add_f32 v242, v242, v241
  v_cvt_pk_bf16_f32 v34, v28, v29
  v_add_f32 v240, v240, v242
  v_cvt_pk_bf16_f32 v35, v30, v31
  v_add_f32 v19, v19, v240
  s_waitcnt vmcnt(0)
  s_cmp_ge_u32 s41, 128
  s_cbranch_scc1 L_nok_4
  s_lshl_b32 s40, s41, 14
  s_add_u32 s42, s40, 0
  s_add_u32 m0, s43, 0
  s_nop 0
  buffer_load_dwordx4 v4, s[32:35], s42 offen offset:0 nt lds
  buffer_load_dwordx4 v5, s[32:35], s42 offen offset:1024 nt lds
  buffer_load_dwordx4 v6, s[32:35], s42 offen offset:2048 nt lds
  buffer_load_dwordx4 v7, s[32:35], s42 offen offset:3072 nt lds
  s_add_u32 s42, s40, 4096
  s_add_u32 m0, s43, 4096
  s_nop 0
  buffer_load_dwordx4 v8, s[32:35], s42 offen offset:0 nt lds
  buffer_load_dwordx4 v9, s[32:35], s42 offen offset:1024 nt lds
  buffer_load_dwordx4 v10, s[32:35], s42 offen offset:2048 nt lds
  buffer_load_dwordx4 v11, s[32:35], s42 offen offset:3072 nt lds
  s_add_u32 s42, s40, 8192
  s_add_u32 m0, s43, 8192
  s_nop 0
  buffer_load_dwordx4 v4, s[32:35], s42 offen offset:0 nt lds
  buffer_load_dwordx4 v5, s[32:35], s42 offen offset:1024 nt lds
  buffer_load_dwordx4 v6, s[32:35], s42 offen offset:2048 nt lds
  buffer_load_dwordx4 v7, s[32:35], s42 offen offset:3072 nt lds
  s_add_u32 s42, s40, 12288
  s_add_u32 m0, s43, 12288
  s_nop 0
  buffer_load_dwordx4 v8, s[32:35], s42 offen offset:0 nt lds
  buffer_load_dwordx4 v9, s[32:35], s42 offen offset:1024 nt lds
  buffer_load_dwordx4 v10, s[32:35], s42 offen offset:2048 nt lds
  buffer_load_dwordx4 v11, s[32:35], s42 offen offset:3072 nt lds
  s_cmp_ge_u32 s41, 124
  s_cselect_b32 s71, 1, 0
  s_cbranch_scc0 L_nok_4
  s_add_u32 s42, s40, 0
  buffer_load_dwordx4 v[112:115], v12, s[36:39], s42 offen offset:0 nt
  buffer_load_dwordx4 v[116:119], v12, s[36:39], s42 offen offset:256 nt
  buffer_load_dwordx4 v[120:123], v12, s[36:39], s42 offen offset:2048 nt
  buffer_load_dwordx4 v[124:127], v12, s[36:39], s42 offen offset:2304 nt
  s_add_u32 s42, s40, 4096
  buffer_load_dwordx4 v[128:131], v12, s[36:39], s42 offen offset:0 nt
  buffer_load_dwordx4 v[132:135], v12, s[36:39], s42 offen offset:256 nt
  buffer_load_dwordx4 v[136:139], v12, s[36:39], s42 offen offset:2048 nt
  buffer_load_dwordx4 v[140:143], v12, s[36:39], s42 offen offset:2304 nt
  s_add_u32 s42, s40, 8192
  buffer_load_dwordx4 v[144:147], v12, s[36:39], s42 offen offset:0 nt
  buffer_load_dwordx4 v[148:151], v12, s[36:39], s42 offen offset:256 nt
  buffer_load_dwordx4 v[152:155], v12, s[36:39], s42 offen offset:2048 nt
  buffer_load_dwordx4 v[156:159], v12, s[36:39], s42 offen offset:2304 nt
  s_add_u32 s42, s40, 12288
  buffer_load_dwordx4 v[160:163], v12, s[36:39], s42 offen offset:0 nt
  buffer_load_dwordx4 v[164:167], v12, s[36:39], s42 offen offset:256 nt
  buffer_load_dwordx4 v[168:171], v12, s[36:39], s42 offen offset:2048 nt
  buffer_load_dwordx4 v[172:175], v12, s[36:39], s42 offen offset:2304 nt
L_nok_4:
  v_perm_b32 v36, v184, v176, s45
  v_perm_b32 v37, v200, v192, s45
  v_perm_b32 v38, v216, v208, s45
  v_perm_b32 v39, v232, v224, s45
  v_perm_b32 v40, v184, v176, s46
  v_perm_b32 v41, v200, v192, s46
  v_perm_b32 v42, v216, v208, s46
  v_perm_b32 v43, v232, v224, s46
  v_mfma_f32_16x16x32_bf16 v[48:51], v[36:39], v[32:35], v[48:51]
  v_perm_b32 v44, v185, v177, s45
  v_perm_b32 v45, v201, v193, s45
  v_perm_b32 v46, v217, v209, s45
  v_perm_b32 v47, v233, v225, s45
  v_mfma_f32_16x16x32_bf16 v[52:55], v[40:43], v[32:35], v[52:55]
  v_perm_b32 v36, v185, v177, s46
  v_perm_b32 v37, v201, v193, s46
  v_perm_b32 v38, v217, v209, s46
  v_perm_b32 v39, v233, v225, s46
  v_mfma_f32_16x16x32_bf16 v[56:59], v[44:47], v[32:35], v[56:59]
  v_perm_b32 v40, v186, v178, s45
  v_perm_b32 v41, v202, v194, s45
  v_perm_b32 v42, v218, v210, s45
  v_perm_b32 v43, v234, v226, s45
  v_mfma_f32_16x16x32_bf16 v[60:63], v[36:39], v[32:35], v[60:63]
  v_perm_b32 v44, v186, v178, s46
  v_perm_b32 v45, v202, v194, s46
  v_perm_b32 v46, v218, v210, s46
  v_perm_b32 v47, v234, v226, s46
  v_mfma_f32_16x16x32_bf16 v[64:67], v[40:43], v[32:35], v[64:67]
  v_perm_b32 v36, v187, v179, s45
  v_perm_b32 v37, v203, v195, s45
  v_perm_b32 v38, v219, v211, s45
  v_perm_b32 v39, v235, v227, s45
  v_mfma_f32_16x16x32_bf16 v[68:71], v[44:47], v[32:35], v[68:71]
  v_perm_b32 v40, v187, v179, s46
  v_perm_b32 v41, v203, v195, s46
  v_perm_b32 v42, v219, v211, s46
  v_perm_b32 v43, v235, v227, s46
  v_mfma_f32_16x16x32_bf16 v[72:75], v[36:39], v[32:35], v[72:75]
  v_perm_b32 v44, v188, v180, s45
  v_perm_b32 v45, v204, v196, s45
  v_perm_b32 v46, v220, v212, s45
  v_perm_b32 v47, v236, v228, s45
  v_mfma_f32_16x16x32_bf16 v[76:79], v[40:43], v[32:35], v[76:79]
  v_perm_b32 v36, v188, v180, s46
  v_perm_b32 v37, v204, v196, s46
  v_perm_b32 v38, v220, v212, s46
  v_perm_b32 v39, v236, v228, s46
  v_mfma_f32_16x16x32_bf16 v[80:83], v[44:47], v[32:35], v[80:83]
  v_perm_b32 v40, v189, v181, s45
  v_perm_b32 v41, v205, v197, s45
  v_perm_b32 v42, v221, v213, s45
  v_perm_b32 v43, v237, v229, s45
  v_mfma_f32_16x16x32_bf16 v[84:87], v[36:39], v[32:35], v[84:87]
  v_perm_b32 v44, v189, v181, s46
  v_perm_b32 v45, v205, v197, s46
  v_perm_b32 v46, v221, v213, s46
  v_perm_b32 v47, v237, v229, s46
  v_mfma_f32_16x16x32_bf16 v[88:91], v[40:43], v[32:35], v[88:91]
  v_perm_b32 v36, v190, v182, s45
  v_perm_b32 v37, v206, v198, s45
  v_perm_b32 v38, v222, v214, s45
  v_perm_b32 v39, v238, v230, s45
  v_mfma_f32_16x16x32_bf16 v[92:95], v[44:47], v[32:35], v[92:95]
  v_perm_b32 v40, v190, v182, s46
  v_perm_b32 v41, v206, v198, s46
  v_perm_b32 v42, v222, v214, s46
  v_perm_b32 v43, v238, v230, s46
  v_mfma_f32_16x16x32_bf16 v[96:99], v[36:39], v[32:35], v[96:99]
  v_perm_b32 v44, v191, v183, s45
  v_perm_b32 v45, v207, v199, s45
  v_perm_b32 v46, v223, v215, s45
  v_perm_b32 v47, v239, v231, s45
  v_mfma_f32_16x16x32_bf16 v[100:103], v[40:43], v[32:35], v[100:103]
  v_perm_b32 v36, v191, v183, s46
  v_perm_b32 v37, v207, v199, s46
  v_perm_b32 v38, v223, v215, s46
  v_perm_b32 v39, v239, v231, s46
  v_mfma_f32_16x16x32_bf16 v[104:107], v[44:47], v[32:35], v[104:107]
  s_nop 1
  v_mfma_f32_16x16x32_bf16 v[108:111], v[36:39], v[32:35], v[108:111]
  s_cmp_ge_u32 s41, 128
  s_cbranch_scc1 L_u_done
  s_branch L_u_loop
L_u_done:
  v_mov_b32 v241, v19
  s_nop 1
  v_permlane16_swap_b32 v241, v19
  v_add_f32 v19, v19, v241
  v_mov_b32 v241, v19
  s_nop 1
  v_permlane32_swap_b32 v241, v19
  v_add_f32 v19, v19, v241
  v_and_b32 v2, 1, v1
  v_lshlrev_b32 v3, 3, v2
  v_add_u32 v3, 132128, v3
  s_lshl_b32 s41, s3, 4
  v_add_u32 v3, s41, v3
  v_lshlrev_b32 v2, 10, v2
  v_lshrrev_b32 v23, 4, v1
  v_lshl_add_u32 v2, v23, 7, v2
  v_add_u32 v2, s43, v2
  s_mov_b32 exec_lo, 0x00030003
  s_mov_b32 exec_hi, 0x00030003
  ds_write2_b32 v2, v48, v52 offset0:0 offset1:1
  ds_write2_b32 v2, v56, v60 offset0:2 offset1:3
  ds_write2_b32 v2, v64, v68 offset0:4 offset1:5
  ds_write2_b32 v2, v72, v76 offset0:6 offset1:7
  ds_write2_b32 v2, v49, v53 offset0:8 offset1:9
  ds_write2_b32 v2, v57, v61 offset0:10 offset1:11
  ds_write2_b32 v2, v65, v69 offset0:12 offset1:13
  ds_write2_b32 v2, v73, v77 offset0:14 offset1:15
  ds_write2_b32 v2, v50, v54 offset0:16 offset1:17
  ds_write2_b32 v2, v58, v62 offset0:18 offset1:19
  ds_write2_b32 v2, v66, v70 offset0:20 offset1:21
  ds_write2_b32 v2, v74, v78 offset0:22 offset1:23
  ds_write2_b32 v2, v51, v55 offset0:24 offset1:25
  ds_write2_b32 v2, v59, v63 offset0:26 offset1:27
  ds_write2_b32 v2, v67, v71 offset0:28 offset1:29
  ds_write2_b32 v2, v75, v79 offset0:30 offset1:31
  ds_write2_b32 v2, v80, v84 offset0:128 offset1:129
  ds_write2_b32 v2, v88, v92 offset0:130 offset1:131
  ds_write2_b32 v2, v96, v100 offset0:132 offset1:133
  ds_write2_b32 v2, v104, v108 offset0:134 offset1:135
  ds_write2_b32 v2, v81, v85 offset0:136 offset1:137
  ds_write2_b32 v2, v89, v93 offset0:138 offset1:139
  ds_write2_b32 v2, v97, v101 offset0:140 offset1:141
  ds_write2_b32 v2, v105, v109 offset0:142 offset1:143
  ds_write2_b32 v2, v82, v86 offset0:144 offset1:145
  ds_write2_b32 v2, v90, v94 offset0:146 offset1:147
  ds_write2_b32 v2, v98, v102 offset0:148 offset1:149
  ds_write2_b32 v2, v106, v110 offset0:150 offset1:151
  ds_write2_b32 v2, v83, v87 offset0:152 offset1:153
  ds_write2_b32 v2, v91, v95 offset0:154 offset1:155
  ds_write2_b32 v2, v99, v103 offset0:156 offset1:157
  ds_write2_b32 v2, v107, v111 offset0:158 offset1:159
  s_mov_b64 exec, 3
  ds_write_b64 v3, v[18:19]
  s_mov_b64 exec, -1
  s_waitcnt lgkmcnt(0)
  s_barrier
  s_cmp_lg_u32 s3, 0
  s_cbranch_scc1 L_u_exit
  v_lshrrev_b32 v2, 5, v1
  v_lshlrev_b32 v2, 3, v2
  v_add_u32 v2, 132128, v2
  ds_read_b64 v[24:25], v2 offset:0
  ds_read_b64 v[26:27], v2 offset:16
  ds_read_b64 v[28:29], v2 offset:32
  ds_read_b64 v[30:31], v2 offset:48
  v_lshlrev_b32 v2, 5, v1
  v_add_u32 v3, 0x10000, v2
  ds_read_b128 v[48:51], v2 offset:0
  ds_read_b128 v[52:55], v2 offset:16
  ds_read_b128 v[56:59], v2 offset:32768
  ds_read_b128 v[60:63], v2 offset:32784
  ds_read_b128 v[64:67], v3 offset:0
  ds_read_b128 v[68:71], v3 offset:16
  ds_read_b128 v[72:75], v3 offset:32768
  ds_read_b128 v[76:79], v3 offset:32784
  s_waitcnt lgkmcnt(8)
  v_max3_f32 v240, v24, v26, v28
  v_max_f32 v240, v240, v30
  v_sub_f32 v24, v24, v240
  v_sub_f32 v26, v26, v240
  v_sub_f32 v28, v28, v240
  v_sub_f32 v30, v30, v240
  v_mul_f32 v24, s44, v24
  v_mul_f32 v26, s44, v26
  v_mul_f32 v28, s44, v28
  v_mul_f32 v30, s44, v30
  v_exp_f32 v24, v24
  v_exp_f32 v26, v26
  v_exp_f32 v28, v28
  v_exp_f32 v30, v30
  s_nop 0
  v_mul_f32 v241, v24, v25
  v_fma_f32 v241, v26, v27, v241
  v_fma_f32 v241, v28, v29, v241
  v_fma_f32 v241, v30, v31, v241
  v_rcp_f32 v241, v241
  s_nop 0
  v_mul_f32 v24, v24, v241
  v_mul_f32 v26, v26, v241
  v_mul_f32 v28, v28, v241
  v_mul_f32 v30, v30, v241
  s_waitcnt lgkmcnt(0)
  v_mul_f32 v48, v48, v24
  v_mul_f32 v49, v49, v24
  v_mul_f32 v50, v50, v24
  v_mul_f32 v51, v51, v24
  v_mul_f32 v52, v52, v24
  v_mul_f32 v53, v53, v24
  v_mul_f32 v54, v54, v24
  v_mul_f32 v55, v55, v24
  v_fma_f32 v48, v56, v26, v48
  v_fma_f32 v49, v57, v26, v49
  v_fma_f32 v50, v58, v26, v50
  v_fma_f32 v51, v59, v26, v51
  v_fma_f32 v52, v60, v26, v52
  v_fma_f32 v53, v61, v26, v53
  v_fma_f32 v54, v62, v26, v54
  v_fma_f32 v55, v63, v26, v55
  v_fma_f32 v48, v64, v28, v48
  v_fma_f32 v49, v65, v28, v49
  v_fma_f32 v50, v66, v28, v50
  v_fma_f32 v51, v67, v28, v51
  v_fma_f32 v52, v68, v28, v52
  v_fma_f32 v53, v69, v28, v53
  v_fma_f32 v54, v70, v28, v54
  v_fma_f32 v55, v71, v28, v55
  v_fma_f32 v48, v72, v30, v48
  v_fma_f32 v49, v73, v30, v49
  v_fma_f32 v50, v74, v30, v50
  v_fma_f32 v51, v75, v30, v51
  v_fma_f32 v52, v76, v30, v52
  v_fma_f32 v53, v77, v30, v53
  v_fma_f32 v54, v78, v30, v54
  v_fma_f32 v55, v79, v30, v55
  v_cvt_pk_bf16_f32 v32, v48, v49
  v_cvt_pk_bf16_f32 v33, v50, v51
  v_cvt_pk_bf16_f32 v34, v52, v53
  v_cvt_pk_bf16_f32 v35, v54, v55
  v_lshlrev_b32 v2, 4, v1
  s_cmp_lg_u32 s52, 0
  s_cbranch_scc1 L_u_storeA
  s_mov_b32 exec_hi, 0
L_u_storeA:
  global_store_dwordx4 v2, v[32:35], s[50:51] sc1
  s_mov_b64 exec, -1
  s_cmp_lg_u32 s52, 0
  s_cselect_b32 s41, 1, 2
  s_cselect_b32 s47, 1, 3
  s_cselect_b32 s54, 0, 4
  s_cselect_b32 s55, 3, 4
  s_lshr_b32 s41, s53, s41
  s_add_u32 s41, s41, s54
  s_lshl_b32 s41, s41, 8
  s_and_b32 s47, s53, s47
  s_lshl_b32 s47, s47, 6
  s_add_u32 s41, s41, s47
  s_sub_u32 s47, s2, 64
  s_cmp_lg_u32 s52, 0
  s_cselect_b32 s54, 0, 64
  s_sub_u32 s47, s47, s54
  s_lshr_b32 s47, s47, s55
  s_lshl_b32 s47, s47, 3
  s_add_u32 s41, s41, s47
  s_add_u32 s41, s41, 12288
  v_mov_b32 v2, s41
  v_mov_b32 v242, s30
  v_mov_b32 v243, s31
  s_waitcnt vmcnt(0)
  s_mov_b64 exec, 1
  global_store_dwordx2 v2, v[242:243], s[28:29] sc1
  s_mov_b64 exec, -1
L_u_exit:
  s_endpgm
L_helper0:
  s_lshl_b32 s47, s2, 3
  s_add_u32 s47, s47, 4096
  v_mov_b32 v6, s47
  s_mov_b64 exec, 1
  global_store_dwordx2 v6, v[38:39], s[28:29] sc1
  s_mov_b64 exec, -1
  v_mov_b32 v6, 137216
  ds_write_b64 v6, v[38:39]
  s_waitcnt lgkmcnt(0)
  s_setprio 0
  s_branch L_h_join
L_h_join0:
  s_barrier
L_h_join:
  s_barrier
  s_lshr_b32 s53, s2, 3
  s_and_b32 s52, s2, 7
  s_lshr_b32 s47, s53, 2
  s_lshl_b32 s54, s52, 1
  s_add_u32 s54, s54, s47
  s_add_u32 s55, s52, 6
  s_cmp_ge_u32 s52, 6
  s_cselect_b32 s54, s55, s54
  s_cselect_b32 s47, s47, 0
  s_cmp_lg_u32 s47, 0
  s_cbranch_scc1 L_h_keeper
  s_cmp_ge_u32 s54, 7
  s_cselect_b32 s40, 1, 0
  s_cselect_b32 s47, 7, 0
  s_sub_u32 s54, s54, s47
  s_lshl_b32 s54, s54, 2
  s_and_b32 s47, s53, 3
  s_add_u32 s41, s54, s47
  s_cmp_eq_u32 s40, 0
  s_cselect_b32 s36, s12, s22
  s_cselect_b32 s37, s13, s23
  s_and_b32 s37, s37, 0xffff
  s_mov_b32 s38, 3670016
  s_mov_b32 s39, 0x20000
  v_lshrrev_b32 v2, 4, v1
  v_and_b32 v3, 15, v1
  v_lshrrev_b32 v6, 1, v1
  v_mul_u32_u24 v6, 896, v6
  v_and_b32 v7, 1, v1
  v_lshl_add_u32 v6, v7, 4, v6
  s_mul_i32 s42, s3, 917504
  s_lshl_b32 s47, s41, 5
  s_add_u32 s42, s42, s47
  s_lshl_b32 s43, s3, 15
  v_lshrrev_b32 v7, 2, v3
  v_lshlrev_b32 v7, 5, v7
  v_and_b32 v8, 3, v3
  v_lshl_add_u32 v7, v8, 3, v7
  v_lshl_add_u32 v7, v2, 8, v7
  v_add_u32 v7, s43, v7
  s_add_u32 s47, s42, 0
  s_add_u32 m0, s43, 0
  s_nop 0
  buffer_load_dwordx4 v6, s[36:39], s47 offen nt lds
  s_add_u32 s47, s42, 28672
  s_add_u32 m0, s43, 1024
  s_nop 0
  buffer_load_dwordx4 v6, s[36:39], s47 offen nt lds
  s_add_u32 s47, s42, 57344
  s_add_u32 m0, s43, 2048
  s_nop 0
  buffer_load_dwordx4 v6, s[36:39], s47 offen nt lds
  s_add_u32 s47, s42, 86016
  s_add_u32 m0, s43, 3072
  s_nop 0
  buffer_load_dwordx4 v6, s[36:39], s47 offen nt lds
  s_add_u32 s47, s42, 114688
  s_add_u32 m0, s43, 4096
  s_nop 0
  buffer_load_dwordx4 v6, s[36:39], s47 offen nt lds
  s_add_u32 s47, s42, 143360
  s_add_u32 m0, s43, 5120
  s_nop 0
  buffer_load_dwordx4 v6, s[36:39], s47 offen nt lds
  s_add_u32 s47, s42, 172032
  s_add_u32 m0, s43, 6144
  s_nop 0
  buffer_load_dwordx4 v6, s[36:39], s47 offen nt lds
  s_add_u32 s47, s42, 200704
  s_add_u32 m0, s43, 7168
  s_nop 0
  buffer_load_dwordx4 v6, s[36:39], s47 offen nt lds
  s_add_u32 s47, s42, 229376
  s_add_u32 m0, s43, 8192
  s_nop 0
  buffer_load_dwordx4 v6, s[36:39], s47 offen nt lds
  s_add_u32 s47, s42, 258048
  s_add_u32 m0, s43, 9216
  s_nop 0
  buffer_load_dwordx4 v6, s[36:39], s47 offen nt lds
  s_add_u32 s47, s42, 286720
  s_add_u32 m0, s43, 10240
  s_nop 0
  buffer_load_dwordx4 v6, s[36:39], s47 offen nt lds
  s_add_u32 s47, s42, 315392
  s_add_u32 m0, s43, 11264
  s_nop 0
  buffer_load_dwordx4 v6, s[36:39], s47 offen nt lds
  s_add_u32 s47, s42, 344064
  s_add_u32 m0, s43, 12288
  s_nop 0
  buffer_load_dwordx4 v6, s[36:39], s47 offen nt lds
  s_add_u32 s47, s42, 372736
  s_add_u32 m0, s43, 13312
  s_nop 0
  buffer_load_dwordx4 v6, s[36:39], s47 offen nt lds
  s_add_u32 s47, s42, 401408
  s_add_u32 m0, s43, 14336
  s_nop 0
  buffer_load_dwordx4 v6, s[36:39], s47 offen nt lds
  s_add_u32 s47, s42, 430080
  s_add_u32 m0, s43, 15360
  s_nop 0
  buffer_load_dwordx4 v6, s[36:39], s47 offen nt lds
  s_add_u32 s47, s42, 458752
  s_add_u32 m0, s43, 16384
  s_nop 0
  buffer_load_dwordx4 v6, s[36:39], s47 offen nt lds
  s_add_u32 s47, s42, 487424
  s_add_u32 m0, s43, 17408
  s_nop 0
  buffer_load_dwordx4 v6, s[36:39], s47 offen nt lds
  s_add_u32 s47, s42, 516096
  s_add_u32 m0, s43, 18432
  s_nop 0
  buffer_load_dwordx4 v6, s[36:39], s47 offen nt lds
  s_add_u32 s47, s42, 544768
  s_add_u32 m0, s43, 19456
  s_nop 0
  buffer_load_dwordx4 v6, s[36:39], s47 offen nt lds
  s_add_u32 s47, s42, 573440
  s_add_u32 m0, s43, 20480
  s_nop 0
  buffer_load_dwordx4 v6, s[36:39], s47 offen nt lds
  s_add_u32 s47, s42, 602112
  s_add_u32 m0, s43, 21504
  s_nop 0
  buffer_load_dwordx4 v6, s[36:39], s47 offen nt lds
  s_waitcnt vmcnt(0)
  ds_read_b64_tr_b16 a[0:1], v7 offset:0
  ds_read_b64_tr_b16 a[2:3], v7 offset:128
  ds_read_b64_tr_b16 a[4:5], v7 offset:1024
  ds_read_b64_tr_b16 a[6:7], v7 offset:1152
  ds_read_b64_tr_b16 a[8:9], v7 offset:2048
  ds_read_b64_tr_b16 a[10:11], v7 offset:2176
  ds_read_b64_tr_b16 a[12:13], v7 offset:3072
  ds_read_b64_tr_b16 a[14:15], v7 offset:3200
  s_waitcnt lgkmcnt(0)
  ds_read_b64_tr_b16 a[16:17], v7 offset:4096
  ds_read_b64_tr_b16 a[18:19], v7 offset:4224
  ds_read_b64_tr_b16 a[20:21], v7 offset:5120
  ds_read_b64_tr_b16 a[22:23], v7 offset:5248
  ds_read_b64_tr_b16 a[24:25], v7 offset:6144
  ds_read_b64_tr_b16 a[26:27], v7 offset:6272
  ds_read_b64_tr_b16 a[28:29], v7 offset:7168
  ds_read_b64_tr_b16 a[30:31], v7 offset:7296
  s_waitcnt lgkmcnt(0)
  ds_read_b64_tr_b16 a[32:33], v7 offset:8192
  ds_read_b64_tr_b16 a[34:35], v7 offset:8320
  ds_read_b64_tr_b16 a[36:37], v7 offset:9216
  ds_read_b64_tr_b16 a[38:39], v7 offset:9344
  ds_read_b64_tr_b16 a[40:41], v7 offset:10240
  ds_read_b64_tr_b16 a[42:43], v7 offset:10368
  ds_read_b64_tr_b16 a[44:45], v7 offset:11264
  ds_read_b64_tr_b16 a[46:47], v7 offset:11392
  s_waitcnt lgkmcnt(0)
  ds_read_b64_tr_b16 a[48:49], v7 offset:12288
  ds_read_b64_tr_b16 a[50:51], v7 offset:12416
  ds_read_b64_tr_b16 a[52:53], v7 offset:13312
  ds_read_b64_tr_b16 a[54:55], v7 offset:13440
  ds_read_b64_tr_b16 a[56:57], v7 offset:14336
  ds_read_b64_tr_b16 a[58:59], v7 offset:14464
  ds_read_b64_tr_b16 a[60:61], v7 offset:15360
  ds_read_b64_tr_b16 a[62:63], v7 offset:15488
  s_waitcnt lgkmcnt(0)
  ds_read_b64_tr_b16 a[64:65], v7 offset:16384
  ds_read_b64_tr_b16 a[66:67], v7 offset:16512
  ds_read_b64_tr_b16 a[68:69], v7 offset:17408
  ds_read_b64_tr_b16 a[70:71], v7 offset:17536
  ds_read_b64_tr_b16 a[72:73], v7 offset:18432
  ds_read_b64_tr_b16 a[74:75], v7 offset:18560
  ds_read_b64_tr_b16 a[76:77], v7 offset:19456
  ds_read_b64_tr_b16 a[78:79], v7 offset:19584
  s_waitcnt lgkmcnt(0)
  ds_read_b64_tr_b16 a[80:81], v7 offset:20480
  ds_read_b64_tr_b16 a[82:83], v7 offset:20608
  ds_read_b64_tr_b16 a[84:85], v7 offset:21504
  ds_read_b64_tr_b16 a[86:87], v7 offset:21632
  s_waitcnt lgkmcnt(0)
  v_and_b32 v9, 3, v1
  v_lshlrev_b32 v9, 2, v9
  s_lshl_b32 s47, s40, 16
  s_add_u32 s47, s47, 393216
  s_add_u32 s48, s28, s47
  s_addc_u32 s49, s29, 0
  v_and_b32 v10, 7, v1
  v_lshlrev_b32 v10, 13, v10
  v_lshl_add_u32 v10, v2, 4, v10
  s_lshl_b32 s47, s3, 11
  v_add_u32 v10, s47, v10
  s_cmp_eq_u32 s40, 0
  s_cselect_b32 s72, 0, 0
  s_cmp_eq_u32 s40, 0
  s_cselect_b32 s73, 0, 1
  s_cmp_eq_u32 s40, 0
  s_cselect_b32 s74, 1, 2
  s_cmp_eq_u32 s40, 0
  s_cselect_b32 s75, 1, 3
  v_mov_b32 v12, 137216
  ds_read_b64 v[14:15], v12
  s_lshl_b32 s47, s40, 2
  s_add_u32 s47, s47, s3
  s_lshl_b32 s47, s47, 8
  s_add_u32 s47, s47, 12288
  v_and_b32 v9, 31, v1
  v_lshlrev_b32 v9, 3, v9
  v_add_u32 v9, s47, v9
  s_waitcnt lgkmcnt(0)
  v_readfirstlane_b32 s30, v14
  v_readfirstlane_b32 s31, v15
  s_mov_b32 s68, 255
  s_cmp_eq_u32 s40, 0
  s_cselect_b32 s72, s68, 255
  s_mov_b32 s68, 255
  s_cmp_eq_u32 s40, 0
  s_cselect_b32 s73, s68, 65280
  s_mov_b32 s68, 65280
  s_cmp_eq_u32 s40, 0
  s_cselect_b32 s74, s68, 16711680
  s_mov_b32 s68, 65280
  s_cmp_eq_u32 s40, 0
  s_cselect_b32 s75, s68, 4278190080
  s_mov_b32 s56, 262144
L_h_first:
  global_load_dwordx2 v[16:17], v9, s[28:29] sc1
  s_waitcnt vmcnt(0)
  v_cmp_eq_u32 vcc, s30, v16
  v_cmp_eq_u32 s[54:55], s31, v17
  s_nop 1
  s_and_b32 s68, s54, vcc_lo
  s_cmp_lg_u32 s68, 0
  s_cbranch_scc1 L_h_first_ok
  s_sleep 4
  s_sub_u32 s56, s56, 1
  s_cmp_lg_u32 s56, 0
  s_cbranch_scc1 L_h_first
L_h_first_ok:
  s_add_u32 s47, s42, 630784
  s_add_u32 m0, s43, 22528
  s_nop 0
  buffer_load_dwordx4 v6, s[36:39], s47 offen nt lds
  s_add_u32 s47, s42, 659456
  s_add_u32 m0, s43, 23552
  s_nop 0
  buffer_load_dwordx4 v6, s[36:39], s47 offen nt lds
  s_add_u32 s47, s42, 688128
  s_add_u32 m0, s43, 24576
  s_nop 0
  buffer_load_dwordx4 v6, s[36:39], s47 offen nt lds
  s_add_u32 s47, s42, 716800
  s_add_u32 m0, s43, 25600
  s_nop 0
  buffer_load_dwordx4 v6, s[36:39], s47 offen nt lds
  s_add_u32 s47, s42, 745472
  s_add_u32 m0, s43, 26624
  s_nop 0
  buffer_load_dwordx4 v6, s[36:39], s47 offen nt lds
  s_add_u32 s47, s42, 774144
  s_add_u32 m0, s43, 27648
  s_nop 0
  buffer_load_dwordx4 v6, s[36:39], s47 offen nt lds
  s_add_u32 s47, s42, 802816
  s_add_u32 m0, s43, 28672
  s_nop 0
  buffer_load_dwordx4 v6, s[36:39], s47 offen nt lds
  s_add_u32 s47, s42, 831488
  s_add_u32 m0, s43, 29696
  s_nop 0
  buffer_load_dwordx4 v6, s[36:39], s47 offen nt lds
  s_add_u32 s47, s42, 860160
  s_add_u32 m0, s43, 30720
  s_nop 0
  buffer_load_dwordx4 v6, s[36:39], s47 offen nt lds
  s_add_u32 s47, s42, 888832
  s_add_u32 m0, s43, 31744
  s_nop 0
  buffer_load_dwordx4 v6, s[36:39], s47 offen nt lds
  s_waitcnt vmcnt(0)
  ds_read_b64_tr_b16 a[88:89], v7 offset:22528
  ds_read_b64_tr_b16 a[90:91], v7 offset:22656
  ds_read_b64_tr_b16 a[92:93], v7 offset:23552
  ds_read_b64_tr_b16 a[94:95], v7 offset:23680
  s_waitcnt lgkmcnt(0)
  ds_read_b64_tr_b16 a[96:97], v7 offset:24576
  ds_read_b64_tr_b16 a[98:99], v7 offset:24704
  ds_read_b64_tr_b16 a[100:101], v7 offset:25600
  ds_read_b64_tr_b16 a[102:103], v7 offset:25728
  ds_read_b64_tr_b16 a[104:105], v7 offset:26624
  ds_read_b64_tr_b16 a[106:107], v7 offset:26752
  ds_read_b64_tr_b16 a[108:109], v7 offset:27648
  ds_read_b64_tr_b16 a[110:111], v7 offset:27776
  s_waitcnt lgkmcnt(0)
  ds_read_b64_tr_b16 a[112:113], v7 offset:28672
  ds_read_b64_tr_b16 a[114:115], v7 offset:28800
  ds_read_b64_tr_b16 a[116:117], v7 offset:29696
  ds_read_b64_tr_b16 a[118:119], v7 offset:29824
  ds_read_b64_tr_b16 a[120:121], v7 offset:30720
  ds_read_b64_tr_b16 a[122:123], v7 offset:30848
  ds_read_b64_tr_b16 a[124:125], v7 offset:31744
  ds_read_b64_tr_b16 a[126:127], v7 offset:31872
  s_waitcnt lgkmcnt(0)
  s_waitcnt lgkmcnt(0)
  s_mov_b32 s57, 15
  s_mov_b32 s56, 262144
L_h_poll:
  global_load_dwordx2 v[16:17], v9, s[28:29] sc1
  s_waitcnt vmcnt(0)
  v_cmp_eq_u32 vcc, s30, v16
  v_cmp_eq_u32 s[54:55], s31, v17
  s_nop 1
  s_and_b32 s68, s54, vcc_lo
  s_bitcmp1_b32 s57, 0
  s_cbranch_scc0 L_h_skip0
  s_and_b32 s69, s68, s72
  s_cmp_lg_u32 s69, s72
  s_cbranch_scc1 L_h_skip0
  s_bitset0_b32 s57, 0
  s_mov_b32 exec_lo, 0x00ff00ff
  s_mov_b32 exec_hi, 0x00ff00ff
  global_load_dwordx4 v[112:115], v10, s[48:49] offset:0 sc1
  global_load_dwordx4 v[116:119], v10, s[48:49] offset:64 sc1
  global_load_dwordx4 v[120:123], v10, s[48:49] offset:128 sc1
  global_load_dwordx4 v[124:127], v10, s[48:49] offset:192 sc1
  global_load_dwordx4 v[128:131], v10, s[48:49] offset:256 sc1
  global_load_dwordx4 v[132:135], v10, s[48:49] offset:320 sc1
  global_load_dwordx4 v[136:139], v10, s[48:49] offset:384 sc1
  global_load_dwordx4 v[140:143], v10, s[48:49] offset:448 sc1
  s_mov_b64 exec, -1
L_h_skip0:
  s_bitcmp1_b32 s57, 1
  s_cbranch_scc0 L_h_skip1
  s_and_b32 s69, s68, s73
  s_cmp_lg_u32 s69, s73
  s_cbranch_scc1 L_h_skip1
  s_bitset0_b32 s57, 1
  s_mov_b32 exec_lo, 0x00ff00ff
  s_mov_b32 exec_hi, 0x00ff00ff
  global_load_dwordx4 v[144:147], v10, s[48:49] offset:512 sc1
  global_load_dwordx4 v[148:151], v10, s[48:49] offset:576 sc1
  global_load_dwordx4 v[152:155], v10, s[48:49] offset:640 sc1
  global_load_dwordx4 v[156:159], v10, s[48:49] offset:704 sc1
  global_load_dwordx4 v[160:163], v10, s[48:49] offset:768 sc1
  global_load_dwordx4 v[164:167], v10, s[48:49] offset:832 sc1
  global_load_dwordx4 v[168:171], v10, s[48:49] offset:896 sc1
  global_load_dwordx4 v[172:175], v10, s[48:49] offset:960 sc1
  s_mov_b64 exec, -1
L_h_skip1:
  s_bitcmp1_b32 s57, 2
  s_cbranch_scc0 L_h_skip2
  s_and_b32 s69, s68, s74
  s_cmp_lg_u32 s69, s74
  s_cbranch_scc1 L_h_skip2
  s_bitset0_b32 s57, 2
  s_mov_b32 exec_lo, 0x00ff00ff
  s_mov_b32 exec_hi, 0x00ff00ff
  global_load_dwordx4 v[176:179], v10, s[48:49] offset:1024 sc1
  global_load_dwordx4 v[180:183], v10, s[48:49] offset:1088 sc1
  global_load_dwordx4 v[184:187], v10, s[48:49] offset:1152 sc1
  global_load_dwordx4 v[188:191], v10, s[48:49] offset:1216 sc1
  global_load_dwordx4 v[192:195], v10, s[48:49] offset:1280 sc1
  global_load_dwordx4 v[196:199], v10, s[48:49] offset:1344 sc1
  global_load_dwordx4 v[200:203], v10, s[48:49] offset:1408 sc1
  global_load_dwordx4 v[204:207], v10, s[48:49] offset:1472 sc1
  s_mov_b64 exec, -1
L_h_skip2:
  s_bitcmp1_b32 s57, 3
  s_cbranch_scc0 L_h_skip3
  s_and_b32 s69, s68, s75
  s_cmp_lg_u32 s69, s75
  s_cbranch_scc1 L_h_skip3
  s_bitset0_b32 s57, 3
  s_mov_b32 exec_lo, 0x00ff00ff
  s_mov_b32 exec_hi, 0x00ff00ff
  global_load_dwordx4 v[208:211], v10, s[48:49] offset:1536 sc1
  global_load_dwordx4 v[212:215], v10, s[48:49] offset:1600 sc1
  global_load_dwordx4 v[216:219], v10, s[48:49] offset:1664 sc1
  global_load_dwordx4 v[220:223], v10, s[48:49] offset:1728 sc1
  global_load_dwordx4 v[224:227], v10, s[48:49] offset:1792 sc1
  global_load_dwordx4 v[228:231], v10, s[48:49] offset:1856 sc1
  global_load_dwordx4 v[232:235], v10, s[48:49] offset:1920 sc1
  global_load_dwordx4 v[236:239], v10, s[48:49] offset:1984 sc1
  s_mov_b64 exec, -1
L_h_skip3:
  s_cmp_eq_u32 s57, 0
  s_cbranch_scc1 L_h_ready
  s_sleep 4
  s_sub_u32 s56, s56, 1
  s_cmp_lg_u32 s56, 0
  s_cbranch_scc1 L_h_poll
L_h_ready:
  s_waitcnt vmcnt(0)
  v_mfma_f32_16x16x32_bf16 v[48:51], v[112:115], a[0:3], 0
  v_mfma_f32_16x16x32_bf16 v[52:55], v[116:119], a[4:7], 0
  v_mfma_f32_16x16x32_bf16 v[56:59], v[120:123], a[8:11], 0
  v_mfma_f32_16x16x32_bf16 v[60:63], v[124:127], a[12:15], 0
  v_mfma_f32_16x16x32_bf16 v[48:51], v[128:131], a[16:19], v[48:51]
  v_mfma_f32_16x16x32_bf16 v[52:55], v[132:135], a[20:23], v[52:55]
  v_mfma_f32_16x16x32_bf16 v[56:59], v[136:139], a[24:27], v[56:59]
  v_mfma_f32_16x16x32_bf16 v[60:63], v[140:143], a[28:31], v[60:63]
  v_mfma_f32_16x16x32_bf16 v[48:51], v[144:147], a[32:35], v[48:51]
  v_mfma_f32_16x16x32_bf16 v[52:55], v[148:151], a[36:39], v[52:55]
  v_mfma_f32_16x16x32_bf16 v[56:59], v[152:155], a[40:43], v[56:59]
  v_mfma_f32_16x16x32_bf16 v[60:63], v[156:159], a[44:47], v[60:63]
  v_mfma_f32_16x16x32_bf16 v[48:51], v[160:163], a[48:51], v[48:51]
  v_mfma_f32_16x16x32_bf16 v[52:55], v[164:167], a[52:55], v[52:55]
  v_mfma_f32_16x16x32_bf16 v[56:59], v[168:171], a[56:59], v[56:59]
  v_mfma_f32_16x16x32_bf16 v[60:63], v[172:175], a[60:63], v[60:63]
  v_mfma_f32_16x16x32_bf16 v[48:51], v[176:179], a[64:67], v[48:51]
  v_mfma_f32_16x16x32_bf16 v[52:55], v[180:183], a[68:71], v[52:55]
  v_mfma_f32_16x16x32_bf16 v[56:59], v[184:187], a[72:75], v[56:59]
  v_mfma_f32_16x16x32_bf16 v[60:63], v[188:191], a[76:79], v[60:63]
  v_mfma_f32_16x16x32_bf16 v[48:51], v[192:195], a[80:83], v[48:51]
  v_mfma_f32_16x16x32_bf16 v[52:55], v[196:199], a[84:87], v[52:55]
  v_mfma_f32_16x16x32_bf16 v[56:59], v[200:203], a[88:91], v[56:59]
  v_mfma_f32_16x16x32_bf16 v[60:63], v[204:207], a[92:95], v[60:63]
  v_mfma_f32_16x16x32_bf16 v[48:51], v[208:211], a[96:99], v[48:51]
  v_mfma_f32_16x16x32_bf16 v[52:55], v[212:215], a[100:103], v[52:55]
  v_mfma_f32_16x16x32_bf16 v[56:59], v[216:219], a[104:107], v[56:59]
  v_mfma_f32_16x16x32_bf16 v[60:63], v[220:223], a[108:111], v[60:63]
  v_mfma_f32_16x16x32_bf16 v[48:51], v[224:227], a[112:115], v[48:51]
  v_mfma_f32_16x16x32_bf16 v[52:55], v[228:231], a[116:119], v[52:55]
  v_mfma_f32_16x16x32_bf16 v[56:59], v[232:235], a[120:123], v[56:59]
  v_mfma_f32_16x16x32_bf16 v[60:63], v[236:239], a[124:127], v[60:63]
  v_lshlrev_b32 v6, 8, v2
  v_lshl_add_u32 v6, v3, 2, v6
  s_lshl_b32 s47, s3, 9
  s_add_u32 s47, s47, 135168
  v_add_u32 v6, s47, v6
  s_nop 7
  v_add_f32 v48, v48, v52
  v_add_f32 v56, v56, v60
  v_add_f32 v49, v49, v53
  v_add_f32 v57, v57, v61
  v_add_f32 v50, v50, v54
  v_add_f32 v58, v58, v62
  v_add_f32 v51, v51, v55
  v_add_f32 v59, v59, v63
  v_add_f32 v48, v48, v56
  v_add_f32 v49, v49, v57
  v_add_f32 v50, v50, v58
  v_add_f32 v51, v51, v59
  s_mov_b32 exec_hi, 0
  ds_write_b32 v6, v48 offset:0
  ds_write_b32 v6, v49 offset:64
  ds_write_b32 v6, v50 offset:128
  ds_write_b32 v6, v51 offset:192
  s_mov_b64 exec, -1
  s_waitcnt lgkmcnt(0)
  s_barrier
  s_cmp_lg_u32 s3, 0
  s_cbranch_scc1 L_h_exit
  v_lshlrev_b32 v6, 3, v1
  v_add_u32 v6, 135168, v6
  ds_read_b64 v[48:49], v6 offset:0
  ds_read_b64 v[50:51], v6 offset:512
  ds_read_b64 v[52:53], v6 offset:1024
  ds_read_b64 v[54:55], v6 offset:1536
  v_lshrrev_b32 v6, 3, v1
  v_mul_u32_u24 v6, 1792, v6
  v_and_b32 v7, 7, v1
  v_lshl_add_u32 v6, v7, 2, v6
  s_mul_i32 s47, s40, 896
  s_lshl_b32 s48, s41, 5
  s_add_u32 s47, s47, s48
  v_add_u32 v6, s47, v6
  s_waitcnt lgkmcnt(0)
  v_add_f32 v48, v48, v50
  v_add_f32 v49, v49, v51
  v_add_f32 v52, v52, v54
  v_add_f32 v53, v53, v55
  v_add_f32 v48, v48, v52
  v_add_f32 v49, v49, v53
  v_cvt_pk_bf16_f32 v48, v48, v49
  global_store_dword v6, v48, s[24:25]
  s_branch L_h_exit
L_h_keeper:
  s_cmp_lg_u32 s2, 62
  s_cbranch_scc1 L_h_exit
  s_cmp_lg_u32 s3, 0
  s_cbranch_scc1 L_h_exit
  v_min_u32 v2, 23, v1
  v_cmp_gt_u32 vcc, 8, v2
  v_lshrrev_b32 v3, 1, v2
  v_lshlrev_b32 v3, 7, v3
  v_and_b32 v4, 1, v2
  v_lshl_add_u32 v3, v4, 2, v3
  v_subrev_u32 v4, 8, v2
  v_lshrrev_b32 v5, 2, v4
  v_add_u32 v5, 4, v5
  v_lshlrev_b32 v5, 7, v5
  v_and_b32 v4, 3, v4
  v_lshl_add_u32 v4, v4, 2, v5
  v_cndmask_b32 v3, v4, v3, vcc
  v_add_u32 v3, 8192, v3
  v_lshlrev_b32 v4, 3, v1
  v_add_u32 v4, 4096, v4
  s_mov_b32 s56, 262144
L_k_h:
  global_load_dwordx2 v[6:7], v4, s[28:29] sc1
  s_waitcnt vmcnt(0)
  v_cmp_eq_u32 s[54:55], s30, v6
  v_cmp_eq_u32 s[68:69], s31, v7
  s_nop 1
  s_and_b64 s[54:55], s[54:55], s[68:69]
  s_cmp_eq_u64 s[54:55], -1
  s_cbranch_scc1 L_k_h2
  s_sleep 8
  s_sub_u32 s56, s56, 1
  s_cmp_lg_u32 s56, 0
  s_cbranch_scc1 L_k_h
L_k_h2:
  s_mov_b32 s56, 262144
  v_lshlrev_b32 v3, 3, v1
  v_add_u32 v3, 12288, v3
  v_and_b32 v5, 16, v1
  v_cmp_ne_u32 s[70:71], 0, v5
L_k_poll:
  global_load_dwordx2 v[8:9], v3, s[28:29] offset:0 sc1
  global_load_dwordx2 v[10:11], v3, s[28:29] offset:512 sc1
  global_load_dwordx2 v[12:13], v3, s[28:29] offset:1024 sc1
  global_load_dwordx2 v[14:15], v3, s[28:29] offset:1536 sc1
  s_waitcnt vmcnt(0)
  s_mov_b64 s[68:69], -1
  v_cmp_eq_u32 vcc, s30, v8
  v_cmp_eq_u32 s[54:55], s31, v9
  s_nop 1
  s_and_b64 s[54:55], s[54:55], vcc
  s_or_b64 s[54:55], s[54:55], s[70:71]
  s_and_b64 s[68:69], s[68:69], s[54:55]
  v_cmp_eq_u32 vcc, s30, v10
  v_cmp_eq_u32 s[54:55], s31, v11
  s_nop 1
  s_and_b64 s[54:55], s[54:55], vcc
  s_or_b64 s[54:55], s[54:55], s[70:71]
  s_and_b64 s[68:69], s[68:69], s[54:55]
  v_cmp_eq_u32 vcc, s30, v12
  v_cmp_eq_u32 s[54:55], s31, v13
  s_nop 1
  s_and_b64 s[54:55], s[54:55], vcc
  s_and_b64 s[68:69], s[68:69], s[54:55]
  v_cmp_eq_u32 vcc, s30, v14
  v_cmp_eq_u32 s[54:55], s31, v15
  s_nop 1
  s_and_b64 s[54:55], s[54:55], vcc
  s_and_b64 s[68:69], s[68:69], s[54:55]
  s_cmp_eq_u64 s[68:69], -1
  s_cbranch_scc1 L_k_done
  s_sleep 8
  s_sub_u32 s56, s56, 1
  s_cmp_lg_u32 s56, 0
  s_cbranch_scc1 L_k_poll
L_k_done:
  v_mov_b32 v2, 0
  v_mov_b32 v6, s30
  v_mov_b32 v7, s31
  s_mov_b64 exec, 1
  global_store_dwordx2 v2, v[6:7], s[28:29] offset:0 sc1
  s_mov_b64 exec, -1
L_h_exit:
L_end:
  s_endpgm
.section .rodata,"a"
.p2align 6
.amdhsa_kernel concat_heads__gqa_block_cached__mha_block_cached__decode_kernel
  .amdhsa_next_free_vgpr 384
  .amdhsa_next_free_sgpr 96
  .amdhsa_accum_offset 256
  .amdhsa_group_segment_fixed_size 0
  .amdhsa_kernarg_size 104
  .amdhsa_user_sgpr_count 2
  .amdhsa_user_sgpr_kernarg_segment_ptr 1
  .amdhsa_system_sgpr_workgroup_id_x 1
.end_amdhsa_kernel
```
